```python
import torch

def _softmax(x, axis=-1):
    return torch.softmax(x, dim=axis)
def _gelu(x):
    return torch.nn.functional.gelu(x, approximate="tanh")
def _silu(x):
    return torch.nn.functional.silu(x)
def _sigmoid(x):
    return torch.sigmoid(x)
def _layernorm(x, axis=-1, eps=1e-5):
    m = x.mean(dim=axis, keepdim=True)
    v = x.var(dim=axis, keepdim=True, unbiased=False)
    return (x - m) / torch.sqrt(v + eps)
def _scatter_add(tgt, idx, src, axis=0):
    return tgt.clone().index_add_(axis, idx, src)
def _segment_sum(src, seg, n):
    out = torch.zeros((n,) + src.shape[1:], dtype=src.dtype)
    return out.index_add_(0, seg, src)
def _pad(x, pw):
    flat = tuple(v for pair in reversed(pw) for v in pair)
    return torch.nn.functional.pad(x, flat)

kernel_name = 'interleave_layers__grouped_kv_mqa__sliding_block__prompt'

def setup_inputs():

    _w = (lambda a: (lambda t: t.to(torch.bfloat16) if t.is_floating_point() else t)(torch.as_tensor(a)))
    def _A_setup():
        B, S, D, H = 1, 2048, 448, 16
        Dh = D // H
        return {
            "x": _w((lambda *s: torch.randn(*s, dtype=torch.bfloat16) * 0.05)(B, S, D)),
            "wq": _w((lambda *s: torch.randn(*s, dtype=torch.bfloat16) * 0.05)(D, H * Dh)),
            "wk": _w((lambda *s: torch.randn(*s, dtype=torch.bfloat16) * 0.05)(D, Dh)),
            "wv": _w((lambda *s: torch.randn(*s, dtype=torch.bfloat16) * 0.05)(D, Dh)),
            "wo": _w((lambda *s: torch.randn(*s, dtype=torch.bfloat16) * 0.05)(H * Dh, D)),
        }
    _A_in = _A_setup()

    def _B_setup():
        B, S, D = 1, 2048, 448
        return {
            "x": _w((lambda *s: torch.randn(*s, dtype=torch.bfloat16) * 0.05)(B, S, D)),
            "wqkv": _w((lambda *s: torch.randn(*s, dtype=torch.bfloat16) * 0.05)(D, 3 * D)),
            "wo": _w((lambda *s: torch.randn(*s, dtype=torch.bfloat16) * 0.05)(D, D)),
        }
    _B_in = _B_setup()

    return {
        "A_x": _A_in["x"],
        "A_wq": _A_in["wq"],
        "A_wk": _A_in["wk"],
        "A_wv": _A_in["wv"],
        "A_wo": _A_in["wo"],
        "B_x": _B_in["x"],
        "B_wqkv": _B_in["wqkv"],
        "B_wo": _B_in["wo"],
    }

def reference(A_x, A_wq, A_wk, A_wv, A_wo, B_x, B_wqkv, B_wo):
    def _A_ref(x, wq, wk, wv, wo):
        B, S, D = x.shape
        H = 16
        Dh = D // H
        q = (lambda x, *d: x.permute(*d))((x @ wq).reshape(B, S, H, Dh), 0, 2, 1, 3)
        k = x @ wk
        v = x @ wv
        scores = torch.einsum("bhqd,bkd->bhqk", q, k) * (Dh ** -0.5)
        p = _softmax(scores, axis=-1)
        o = torch.einsum("bhqk,bkd->bhqd", p, v)
        return (lambda x, *d: x.permute(*d))(o, 0, 2, 1, 3).reshape(B, S, H * Dh) @ wo

    def _B_ref(x, wqkv, wo):
        B, S, D = x.shape
        H = 16; Dh = D // H; W = 256
        qkv = (lambda x, *d: x.permute(*d))((x @ wqkv).reshape(B, S, 3, H, Dh), 2, 0, 3, 1, 4)
        q, k, v = qkv[0], qkv[1], qkv[2]
        scores = torch.einsum("bhqd,bhkd->bhqk", q, k) * (Dh ** -0.5)
        idx = torch.arange(S)
        mask = (idx[:, None] - idx[None, :] >= 0) & (idx[:, None] - idx[None, :] < W)
        scores = torch.where(mask[None, None], scores, -1e9)
        p = _softmax(scores, axis=-1)
        o = torch.einsum("bhqk,bhkd->bhqd", p, v)
        return (lambda x, *d: x.permute(*d))(o, 0, 2, 1, 3).reshape(B, S, D) @ wo

    x = A_x
    x = x + _A_ref(_layernorm(x, axis=-1), A_wq, A_wk, A_wv, A_wo)
    x = x + _B_ref(_layernorm(x, axis=-1), B_wqkv, B_wo)
    x = x + _A_ref(_layernorm(x, axis=-1), A_wq, A_wk, A_wv, A_wo)
    x = x + _B_ref(_layernorm(x, axis=-1), B_wqkv, B_wo)
    return x
```

```asm
; @launch grid=(256,1,1) block=(512,1,1) lds=163840
.amdgcn_target "amdgcn-amd-amdhsa--gfx950"
.text
.globl interleave_layers__grouped_kv_mqa__sliding_block__prompt_kernel
.p2align 8
.type interleave_layers__grouped_kv_mqa__sliding_block__prompt_kernel,@function
interleave_layers__grouped_kv_mqa__sliding_block__prompt_kernel:
    s_cmp_ge_u32 s2, 256
    s_cbranch_scc1 L_exit
    s_load_dwordx16 s[16:31], s[0:1], 0
    s_load_dwordx4 s[44:47], s[0:1], 56
    s_load_dwordx4 s[48:51], s[0:1], 72
    s_memrealtime s[70:71]
    v_lshrrev_b32 v1, 6, v0
    v_and_b32 v2, 63, v0
    v_readfirstlane_b32 s12, v1
    v_and_b32 v3, 31, v2
    v_lshrrev_b32 v4, 5, v2
    v_lshlrev_b32 v5, 4, v2
    v_add_u32 v6, 0x10000, v5
    v_add_u32 v7, 0x20000, v5
    s_and_b32 s13, s2, 7
    s_lshr_b32 s14, s2, 3
    s_mov_b32 s62, 0
    s_mov_b32 s10, 0x10000000
    s_mov_b32 s11, 0x00020000
    s_mov_b32 s60, 0x400000
    s_mov_b32 s61, 0x310000
    s_waitcnt lgkmcnt(0)
    s_mov_b64 s[8:9], s[50:51]
    s_cmp_lg_u32 s2, 0
    s_cbranch_scc1 L_nopub
    s_cmp_lg_u32 s12, 0
    s_cbranch_scc1 L_nopub
    s_memrealtime s[66:67]
    s_mov_b64 s[4:5], s[48:49]
    s_mov_b32 s6, 256
    s_mov_b32 s7, 0x00020000
    s_waitcnt lgkmcnt(0)
    s_or_b32 s66, s66, 1
    s_xor_b32 s67, s67, 0x5bd1e995
    v_mov_b32 v10, 0
    v_mov_b32 v12, s66
    v_mov_b32 v13, s67
    s_mov_b64 exec, 1
    buffer_store_dwordx2 v[12:13], v10, s[4:7], 0 offen sc1
    s_mov_b64 exec, -1
L_nopub:
    s_cmp_lg_u32 s12, 7
    s_cbranch_scc1 L_nocw
    s_getpc_b64 s[36:37]
L_pcref:
    s_lshl_b32 s38, s14, 11
    v_lshlrev_b32 v10, 5, v2
    v_add_u32 v10, s38, v10
    v_min_u32 v10, CODE_LIMIT, v10
    global_load_dword v11, v10, s[36:37]
L_nocw:
    s_cmp_lt_u32 s14, 18
    s_cbranch_scc1 L_first_q0
    s_mul_i32 s52, s13, 14
    s_add_u32 s52, s52, s14
    s_sub_u32 s52, s52, 18
    s_and_b32 s55, s12, 3
    s_lshr_b32 s53, s12, 2
    s_cmp_ge_u32 s52, 64
    s_cbranch_scc1 L_prep_w
    s_cmp_ge_u32 s12, 4
    s_cbranch_scc0 L_prep_xgo
    s_movk_i32 s52, 0x100
    s_branch L_prep_idle
L_prep_xgo:
    s_mov_b64 s[4:5], s[16:17]
    s_mov_b32 s6, 1835008
    s_mov_b32 s7, 0x00020000
    s_lshl_b32 s33, s52, 5
    v_add_u32 v12, s33, v3
    v_mul_u32_u24 v8, 896, v12
    v_lshl_add_u32 v8, v4, 4, v8
    s_mul_i32 s37, s12, 224
    buffer_load_dwordx4 v[16:19], v8, s[4:7], s37 offen offset:0
    buffer_load_dwordx4 v[20:23], v8, s[4:7], s37 offen offset:32
    buffer_load_dwordx4 v[24:27], v8, s[4:7], s37 offen offset:64
    buffer_load_dwordx4 v[28:31], v8, s[4:7], s37 offen offset:96
    buffer_load_dwordx4 v[32:35], v8, s[4:7], s37 offen offset:128
    buffer_load_dwordx4 v[36:39], v8, s[4:7], s37 offen offset:160
    buffer_load_dwordx4 v[40:43], v8, s[4:7], s37 offen offset:192
    s_mul_i32 s38, s52, 28672
    s_mul_i32 s39, s12, 7168
    s_add_u32 s38, s38, s39
    s_add_u32 s38, s38, 0x400000
    s_add_u32 s39, s38, 4096
    v_mov_b32 v8, 0
    v_mov_b32 v9, 0
    v_mov_b32 v12, 0
    v_mov_b32 v13, 0
    v_mov_b32 v14, 0x3f803f80
    s_waitcnt vmcnt(0)
    v_permlane32_swap_b32 v16, v18
    v_permlane32_swap_b32 v17, v19
    buffer_store_dwordx4 v[16:19], v5, s[8:11], s38 offen offset:0 sc1
    v_permlane32_swap_b32 v20, v22
    v_permlane32_swap_b32 v21, v23
    buffer_store_dwordx4 v[20:23], v5, s[8:11], s38 offen offset:1024 sc1
    v_permlane32_swap_b32 v24, v26
    v_permlane32_swap_b32 v25, v27
    buffer_store_dwordx4 v[24:27], v5, s[8:11], s38 offen offset:2048 sc1
    v_permlane32_swap_b32 v28, v30
    v_permlane32_swap_b32 v29, v31
    buffer_store_dwordx4 v[28:31], v5, s[8:11], s38 offen offset:3072 sc1
    v_permlane32_swap_b32 v32, v34
    v_permlane32_swap_b32 v33, v35
    buffer_store_dwordx4 v[32:35], v5, s[8:11], s39 offen offset:0 sc1
    v_permlane32_swap_b32 v36, v38
    v_permlane32_swap_b32 v37, v39
    buffer_store_dwordx4 v[36:39], v5, s[8:11], s39 offen offset:1024 sc1
    v_permlane32_swap_b32 v40, v42
    v_permlane32_swap_b32 v41, v43
    buffer_store_dwordx4 v[40:43], v5, s[8:11], s39 offen offset:2048 sc1
    v_dot2_f32_bf16 v8, v16, v14, v8
    v_dot2_f32_bf16 v9, v16, v16, v9
    v_dot2_f32_bf16 v12, v17, v14, v12
    v_dot2_f32_bf16 v13, v17, v17, v13
    v_dot2_f32_bf16 v8, v18, v14, v8
    v_dot2_f32_bf16 v9, v18, v18, v9
    v_dot2_f32_bf16 v12, v19, v14, v12
    v_dot2_f32_bf16 v13, v19, v19, v13
    v_dot2_f32_bf16 v8, v20, v14, v8
    v_dot2_f32_bf16 v9, v20, v20, v9
    v_dot2_f32_bf16 v12, v21, v14, v12
    v_dot2_f32_bf16 v13, v21, v21, v13
    v_dot2_f32_bf16 v8, v22, v14, v8
    v_dot2_f32_bf16 v9, v22, v22, v9
    v_dot2_f32_bf16 v12, v23, v14, v12
    v_dot2_f32_bf16 v13, v23, v23, v13
    v_dot2_f32_bf16 v8, v24, v14, v8
    v_dot2_f32_bf16 v9, v24, v24, v9
    v_dot2_f32_bf16 v12, v25, v14, v12
    v_dot2_f32_bf16 v13, v25, v25, v13
    v_dot2_f32_bf16 v8, v26, v14, v8
    v_dot2_f32_bf16 v9, v26, v26, v9
    v_dot2_f32_bf16 v12, v27, v14, v12
    v_dot2_f32_bf16 v13, v27, v27, v13
    v_dot2_f32_bf16 v8, v28, v14, v8
    v_dot2_f32_bf16 v9, v28, v28, v9
    v_dot2_f32_bf16 v12, v29, v14, v12
    v_dot2_f32_bf16 v13, v29, v29, v13
    v_dot2_f32_bf16 v8, v30, v14, v8
    v_dot2_f32_bf16 v9, v30, v30, v9
    v_dot2_f32_bf16 v12, v31, v14, v12
    v_dot2_f32_bf16 v13, v31, v31, v13
    v_dot2_f32_bf16 v8, v32, v14, v8
    v_dot2_f32_bf16 v9, v32, v32, v9
    v_dot2_f32_bf16 v12, v33, v14, v12
    v_dot2_f32_bf16 v13, v33, v33, v13
    v_dot2_f32_bf16 v8, v34, v14, v8
    v_dot2_f32_bf16 v9, v34, v34, v9
    v_dot2_f32_bf16 v12, v35, v14, v12
    v_dot2_f32_bf16 v13, v35, v35, v13
    v_dot2_f32_bf16 v8, v36, v14, v8
    v_dot2_f32_bf16 v9, v36, v36, v9
    v_dot2_f32_bf16 v12, v37, v14, v12
    v_dot2_f32_bf16 v13, v37, v37, v13
    v_dot2_f32_bf16 v8, v38, v14, v8
    v_dot2_f32_bf16 v9, v38, v38, v9
    v_dot2_f32_bf16 v12, v39, v14, v12
    v_dot2_f32_bf16 v13, v39, v39, v13
    v_dot2_f32_bf16 v8, v40, v14, v8
    v_dot2_f32_bf16 v9, v40, v40, v9
    v_dot2_f32_bf16 v12, v41, v14, v12
    v_dot2_f32_bf16 v13, v41, v41, v13
    v_dot2_f32_bf16 v8, v42, v14, v8
    v_dot2_f32_bf16 v9, v42, v42, v9
    v_dot2_f32_bf16 v12, v43, v14, v12
    v_dot2_f32_bf16 v13, v43, v43, v13
    s_nop 3
    v_add_f32 v8, v8, v12
    v_add_f32 v9, v9, v13
    v_mov_b32 v10, v8
    v_mov_b32 v11, v9
    s_nop 0
    v_permlane32_swap_b32 v8, v10
    v_permlane32_swap_b32 v9, v11
    v_add_f32 v8, v8, v10
    v_add_f32 v9, v9, v11
    v_lshlrev_b32 v13, 4, v3
    s_lshl_b32 s38, s52, 12
    s_lshl_b32 s39, s12, 9
    s_add_u32 s38, s38, s39
    s_add_u32 s38, s38, 0x5c0000
    v_mov_b32 v10, 0
    v_mov_b32 v11, 0
    v_mov_b32 v14, 0
    v_mov_b32 v15, 0
    v_mov_b32 v16, 0
    v_mov_b32 v17, 0
    buffer_store_dwordx4 v[8:11], v13, s[8:11], s38 offen sc1
    buffer_store_dwordx4 v[14:17], v13, s[8:11], s38 offen offset:2048 sc1
    s_mov_b64 s[4:5], s[48:49]
    s_mov_b32 s6, 256
    s_mov_b32 s7, 0x00020000
    v_mov_b32 v10, 0
    s_mov_b32 s59, 0
L_prep_n1:
    buffer_load_dwordx2 v[12:13], v10, s[4:7], 0 offen sc1
    s_add_u32 s59, s59, 1
    s_waitcnt vmcnt(0)
    v_readfirstlane_b32 s66, v12
    v_readfirstlane_b32 s67, v13
    s_cmp_ge_u32 s59, 0x8000
    s_cbranch_scc1 L_prep_n1_x
    s_cmp_eq_u32 s66, 0
    s_cbranch_scc1 L_prep_n1
    s_sub_u32 s57, s70, s66
    s_cmp_gt_i32 s57, 2000
    s_cbranch_scc1 L_prep_n1
L_prep_n1_x:
    s_lshl_b32 s58, s52, 2
    s_add_u32 s58, s58, s12
    s_add_u32 s58, s58, 96
    s_lshl_b32 s58, s58, 7
    s_add_u32 s58, s58, 0x300000
    v_mov_b32 v125, 0
    v_mov_b32 v126, s66
    v_mov_b32 v127, s67
    s_mov_b64 exec, 1
    buffer_store_dwordx2 v[126:127], v125, s[8:11], s58 offen sc1
    s_mov_b64 exec, -1
    s_movk_i32 s52, 0x100
    s_barrier
    s_barrier
    s_branch L_prep_done
L_prep_idle:
    s_barrier
    s_barrier
    s_branch L_prep_done
L_prep_w:
    s_sub_u32 s52, s52, 64
    s_lshl_b32 s52, s52, 1
    s_add_u32 s52, s52, s53
    s_lshl_b32 s54, s53, 16
    s_cmp_ge_u32 s52, 94
    s_cbranch_scc1 L_prep_idle
    s_cmp_ge_u32 s52, 66
    s_cbranch_scc1 L_prep_wo
    s_cmp_ge_u32 s52, 18
    s_cbranch_scc1 L_prep_qb
    s_mul_i32 s34, s52, 29696
    s_add_u32 s34, s34, 0x0
    s_mov_b32 s7, 0x00020000
    s_cmp_ge_u32 s52, 16
    s_cbranch_scc1 L_prep_a_kv
    s_mov_b64 s[4:5], s[18:19]
    s_mov_b32 s6, 401408
    s_mov_b32 s32, 896
    s_mul_i32 s33, s52, 56
    s_branch L_prep_a_go
L_prep_a_kv:
    s_mov_b64 s[4:5], s[20:21]
    s_cmp_eq_u32 s52, 16
    s_cbranch_scc1 L_prep_a_kv2
    s_mov_b64 s[4:5], s[22:23]
L_prep_a_kv2:
    s_mov_b32 s6, 25088
    s_mov_b32 s32, 56
    s_mov_b32 s33, 0
L_prep_a_go:
    s_branch L_prep_qkv_go
L_prep_qb:
    s_sub_u32 s36, s52, 18
    s_mul_i32 s34, s36, 29696
    s_add_u32 s34, s34, 0x100000
    s_mov_b64 s[4:5], s[28:29]
    s_mov_b32 s6, 1204224
    s_mov_b32 s7, 0x00020000
    s_mov_b32 s32, 2688
    s_mul_i32 s37, s36, 43
    s_lshr_b32 s37, s37, 7
    s_mul_i32 s38, s37, 3
    s_sub_u32 s38, s36, s38
    s_mul_i32 s33, s37, 56
    s_mul_i32 s38, s38, 896
    s_add_u32 s33, s33, s38
L_prep_qkv_go:
    s_add_u32 s35, s34, 28672
    v_lshrrev_b32 v10, 2, v2
    v_mul_lo_u32 v8, v10, s32
    v_and_b32 v10, 3, v2
    v_lshl_add_u32 v8, v10, 4, v8
    v_add_u32 v8, s33, v8
    s_lshl_b32 s36, s32, 4
    s_mul_i32 s37, s36, 7
    s_mul_i32 s37, s37, s55
    s_mul_i32 s38, s55, 7168
    s_add_u32 s40, s38, s54
    s_add_u32 m0, s40, 0
    s_nop 0
    buffer_load_dwordx4 v8, s[4:7], s37 offen lds
    s_add_u32 s37, s37, s36
    s_add_u32 m0, s40, 1024
    s_nop 0
    buffer_load_dwordx4 v8, s[4:7], s37 offen lds
    s_add_u32 s37, s37, s36
    s_add_u32 m0, s40, 2048
    s_nop 0
    buffer_load_dwordx4 v8, s[4:7], s37 offen lds
    s_add_u32 s37, s37, s36
    s_add_u32 m0, s40, 3072
    s_nop 0
    buffer_load_dwordx4 v8, s[4:7], s37 offen lds
    s_add_u32 s37, s37, s36
    s_add_u32 m0, s40, 4096
    s_nop 0
    buffer_load_dwordx4 v8, s[4:7], s37 offen lds
    s_add_u32 s37, s37, s36
    s_add_u32 m0, s40, 5120
    s_nop 0
    buffer_load_dwordx4 v8, s[4:7], s37 offen lds
    s_add_u32 s37, s37, s36
    s_add_u32 m0, s40, 6144
    s_nop 0
    buffer_load_dwordx4 v8, s[4:7], s37 offen lds
    s_add_u32 s37, s37, s36
    v_and_b32 v12, 3, v2
    v_lshlrev_b32 v12, 3, v12
    v_bfe_u32 v10, v2, 2, 2
    v_lshl_add_u32 v12, v10, 6, v12
    v_bfe_u32 v10, v2, 4, 1
    v_lshl_add_u32 v12, v10, 5, v12
    v_lshl_add_u32 v12, v4, 8, v12
    v_add_u32 v12, s40, v12
    s_add_u32 s38, s38, s34
    s_add_u32 s39, s38, 4096
    s_waitcnt vmcnt(0)
    s_barrier
    ds_read_b64_tr_b16 v[16:17], v12 offset:0
    ds_read_b64_tr_b16 v[18:19], v12 offset:512
    ds_read_b64_tr_b16 v[20:21], v12 offset:1024
    ds_read_b64_tr_b16 v[22:23], v12 offset:1536
    ds_read_b64_tr_b16 v[24:25], v12 offset:2048
    ds_read_b64_tr_b16 v[26:27], v12 offset:2560
    ds_read_b64_tr_b16 v[28:29], v12 offset:3072
    ds_read_b64_tr_b16 v[30:31], v12 offset:3584
    ds_read_b64_tr_b16 v[32:33], v12 offset:4096
    ds_read_b64_tr_b16 v[34:35], v12 offset:4608
    ds_read_b64_tr_b16 v[36:37], v12 offset:5120
    ds_read_b64_tr_b16 v[38:39], v12 offset:5632
    ds_read_b64_tr_b16 v[40:41], v12 offset:6144
    ds_read_b64_tr_b16 v[42:43], v12 offset:6656
    s_waitcnt lgkmcnt(0)
    buffer_store_dwordx4 v[16:19], v5, s[8:11], s38 offen offset:0 sc1
    buffer_store_dwordx4 v[20:23], v5, s[8:11], s38 offen offset:1024 sc1
    buffer_store_dwordx4 v[24:27], v5, s[8:11], s38 offen offset:2048 sc1
    buffer_store_dwordx4 v[28:31], v5, s[8:11], s38 offen offset:3072 sc1
    buffer_store_dwordx4 v[32:35], v5, s[8:11], s39 offen offset:0 sc1
    buffer_store_dwordx4 v[36:39], v5, s[8:11], s39 offen offset:1024 sc1
    buffer_store_dwordx4 v[40:43], v5, s[8:11], s39 offen offset:2048 sc1
    v_mov_b32 v8, 0
    v_mov_b32 v9, 0
    v_lshlrev_b32 v10, 16, v16
    v_and_b32 v11, 0xffff0000, v16
    v_add_f32 v8, v8, v10
    v_add_f32 v9, v9, v11
    v_lshlrev_b32 v10, 16, v17
    v_and_b32 v11, 0xffff0000, v17
    v_add_f32 v8, v8, v10
    v_add_f32 v9, v9, v11
    v_lshlrev_b32 v10, 16, v18
    v_and_b32 v11, 0xffff0000, v18
    v_add_f32 v8, v8, v10
    v_add_f32 v9, v9, v11
    v_lshlrev_b32 v10, 16, v19
    v_and_b32 v11, 0xffff0000, v19
    v_add_f32 v8, v8, v10
    v_add_f32 v9, v9, v11
    v_lshlrev_b32 v10, 16, v20
    v_and_b32 v11, 0xffff0000, v20
    v_add_f32 v8, v8, v10
    v_add_f32 v9, v9, v11
    v_lshlrev_b32 v10, 16, v21
    v_and_b32 v11, 0xffff0000, v21
    v_add_f32 v8, v8, v10
    v_add_f32 v9, v9, v11
    v_lshlrev_b32 v10, 16, v22
    v_and_b32 v11, 0xffff0000, v22
    v_add_f32 v8, v8, v10
    v_add_f32 v9, v9, v11
    v_lshlrev_b32 v10, 16, v23
    v_and_b32 v11, 0xffff0000, v23
    v_add_f32 v8, v8, v10
    v_add_f32 v9, v9, v11
    v_lshlrev_b32 v10, 16, v24
    v_and_b32 v11, 0xffff0000, v24
    v_add_f32 v8, v8, v10
    v_add_f32 v9, v9, v11
    v_lshlrev_b32 v10, 16, v25
    v_and_b32 v11, 0xffff0000, v25
    v_add_f32 v8, v8, v10
    v_add_f32 v9, v9, v11
    v_lshlrev_b32 v10, 16, v26
    v_and_b32 v11, 0xffff0000, v26
    v_add_f32 v8, v8, v10
    v_add_f32 v9, v9, v11
    v_lshlrev_b32 v10, 16, v27
    v_and_b32 v11, 0xffff0000, v27
    v_add_f32 v8, v8, v10
    v_add_f32 v9, v9, v11
    v_lshlrev_b32 v10, 16, v28
    v_and_b32 v11, 0xffff0000, v28
    v_add_f32 v8, v8, v10
    v_add_f32 v9, v9, v11
    v_lshlrev_b32 v10, 16, v29
    v_and_b32 v11, 0xffff0000, v29
    v_add_f32 v8, v8, v10
    v_add_f32 v9, v9, v11
    v_lshlrev_b32 v10, 16, v30
    v_and_b32 v11, 0xffff0000, v30
    v_add_f32 v8, v8, v10
    v_add_f32 v9, v9, v11
    v_lshlrev_b32 v10, 16, v31
    v_and_b32 v11, 0xffff0000, v31
    v_add_f32 v8, v8, v10
    v_add_f32 v9, v9, v11
    v_lshlrev_b32 v10, 16, v32
    v_and_b32 v11, 0xffff0000, v32
    v_add_f32 v8, v8, v10
    v_add_f32 v9, v9, v11
    v_lshlrev_b32 v10, 16, v33
    v_and_b32 v11, 0xffff0000, v33
    v_add_f32 v8, v8, v10
    v_add_f32 v9, v9, v11
    v_lshlrev_b32 v10, 16, v34
    v_and_b32 v11, 0xffff0000, v34
    v_add_f32 v8, v8, v10
    v_add_f32 v9, v9, v11
    v_lshlrev_b32 v10, 16, v35
    v_and_b32 v11, 0xffff0000, v35
    v_add_f32 v8, v8, v10
    v_add_f32 v9, v9, v11
    v_lshlrev_b32 v10, 16, v36
    v_and_b32 v11, 0xffff0000, v36
    v_add_f32 v8, v8, v10
    v_add_f32 v9, v9, v11
    v_lshlrev_b32 v10, 16, v37
    v_and_b32 v11, 0xffff0000, v37
    v_add_f32 v8, v8, v10
    v_add_f32 v9, v9, v11
    v_lshlrev_b32 v10, 16, v38
    v_and_b32 v11, 0xffff0000, v38
    v_add_f32 v8, v8, v10
    v_add_f32 v9, v9, v11
    v_lshlrev_b32 v10, 16, v39
    v_and_b32 v11, 0xffff0000, v39
    v_add_f32 v8, v8, v10
    v_add_f32 v9, v9, v11
    v_lshlrev_b32 v10, 16, v40
    v_and_b32 v11, 0xffff0000, v40
    v_add_f32 v8, v8, v10
    v_add_f32 v9, v9, v11
    v_lshlrev_b32 v10, 16, v41
    v_and_b32 v11, 0xffff0000, v41
    v_add_f32 v8, v8, v10
    v_add_f32 v9, v9, v11
    v_lshlrev_b32 v10, 16, v42
    v_and_b32 v11, 0xffff0000, v42
    v_add_f32 v8, v8, v10
    v_add_f32 v9, v9, v11
    v_lshlrev_b32 v10, 16, v43
    v_and_b32 v11, 0xffff0000, v43
    v_add_f32 v8, v8, v10
    v_add_f32 v9, v9, v11
    v_add_f32 v8, v8, v9
    v_lshlrev_b32 v10, 2, v0
    ds_write_b32 v10, v8 offset:32768
    s_waitcnt lgkmcnt(0)
    s_barrier
    s_cmp_lg_u32 s55, 0
    s_cbranch_scc1 L_prep_done
    v_lshlrev_b32 v10, 2, v3
    s_lshl_b32 s38, s53, 10
    v_add_u32 v11, s38, v10
    ds_read_b32 v16, v11 offset:32768
    ds_read_b32 v17, v11 offset:32896
    ds_read_b32 v18, v11 offset:33024
    ds_read_b32 v19, v11 offset:33152
    ds_read_b32 v20, v11 offset:33280
    ds_read_b32 v21, v11 offset:33408
    ds_read_b32 v22, v11 offset:33536
    ds_read_b32 v23, v11 offset:33664
    s_waitcnt lgkmcnt(0)
    v_add_f32 v16, v16, v17
    v_add_f32 v16, v16, v18
    v_add_f32 v16, v16, v19
    v_add_f32 v16, v16, v20
    v_add_f32 v16, v16, v21
    v_add_f32 v16, v16, v22
    v_add_f32 v16, v16, v23
    buffer_store_dword v16, v10, s[8:11], s35 offen sc1
    s_branch L_prep_done
L_prep_wo:
    s_sub_u32 s36, s52, 66
    s_mov_b64 s[4:5], s[24:25]
    s_mov_b32 s34, 0x88000
    s_cmp_lt_u32 s36, 14
    s_cbranch_scc1 L_prep_wo2
    s_sub_u32 s36, s36, 14
    s_mov_b64 s[4:5], s[30:31]
    s_mov_b32 s34, 0x280000
L_prep_wo2:
    s_mov_b32 s6, 401408
    s_mov_b32 s7, 0x00020000
    s_lshl_b32 s37, s36, 15
    s_add_u32 s34, s34, s37
    s_lshl_b32 s33, s36, 6
    s_mov_b32 s32, 896
    v_lshrrev_b32 v10, 2, v2
    v_mul_lo_u32 v8, v10, s32
    v_and_b32 v10, 3, v2
    v_lshl_add_u32 v8, v10, 4, v8
    v_add_u32 v8, s33, v8
    v_cmp_lt_u32 vcc, 47, v2
    v_mov_b32 v10, 0x80000000
    s_nop 0
    v_cndmask_b32 v9, v8, v10, vcc
    s_mul_i32 s37, s55, 100352
    s_lshl_b32 s38, s55, 13
    s_add_u32 s41, s38, s54
    s_add_u32 m0, s41, 0
    s_add_u32 s40, s37, 0
    buffer_load_dwordx4 v8, s[4:7], s40 offen lds
    s_add_u32 m0, s41, 1024
    s_add_u32 s40, s37, 14336
    buffer_load_dwordx4 v9, s[4:7], s40 offen lds
    s_add_u32 m0, s41, 2048
    s_add_u32 s40, s37, 25088
    buffer_load_dwordx4 v8, s[4:7], s40 offen lds
    s_add_u32 m0, s41, 3072
    s_add_u32 s40, s37, 39424
    buffer_load_dwordx4 v9, s[4:7], s40 offen lds
    s_add_u32 m0, s41, 4096
    s_add_u32 s40, s37, 50176
    buffer_load_dwordx4 v8, s[4:7], s40 offen lds
    s_add_u32 m0, s41, 5120
    s_add_u32 s40, s37, 64512
    buffer_load_dwordx4 v9, s[4:7], s40 offen lds
    s_add_u32 m0, s41, 6144
    s_add_u32 s40, s37, 75264
    buffer_load_dwordx4 v8, s[4:7], s40 offen lds
    s_add_u32 m0, s41, 7168
    s_add_u32 s40, s37, 89600
    buffer_load_dwordx4 v9, s[4:7], s40 offen lds
    v_and_b32 v12, 3, v2
    v_lshlrev_b32 v12, 3, v12
    v_bfe_u32 v10, v2, 2, 2
    v_lshl_add_u32 v12, v10, 6, v12
    v_bfe_u32 v10, v2, 4, 1
    v_lshl_add_u32 v12, v10, 5, v12
    v_lshl_add_u32 v12, v4, 8, v12
    v_add_u32 v12, s41, v12
    s_add_u32 s38, s38, s34
    s_add_u32 s39, s38, 4096
    s_waitcnt vmcnt(0)
    s_barrier
    ds_read_b64_tr_b16 v[16:17], v12 offset:0
    ds_read_b64_tr_b16 v[18:19], v12 offset:512
    ds_read_b64_tr_b16 v[20:21], v12 offset:1024
    ds_read_b64_tr_b16 v[22:23], v12 offset:1536
    ds_read_b64_tr_b16 v[24:25], v12 offset:2048
    ds_read_b64_tr_b16 v[26:27], v12 offset:2560
    ds_read_b64_tr_b16 v[28:29], v12 offset:3072
    ds_read_b64_tr_b16 v[30:31], v12 offset:3584
    ds_read_b64_tr_b16 v[32:33], v12 offset:4096
    ds_read_b64_tr_b16 v[34:35], v12 offset:4608
    ds_read_b64_tr_b16 v[36:37], v12 offset:5120
    ds_read_b64_tr_b16 v[38:39], v12 offset:5632
    ds_read_b64_tr_b16 v[40:41], v12 offset:6144
    ds_read_b64_tr_b16 v[42:43], v12 offset:6656
    ds_read_b64_tr_b16 v[44:45], v12 offset:7168
    ds_read_b64_tr_b16 v[46:47], v12 offset:7680
    s_waitcnt lgkmcnt(0)
    buffer_store_dwordx4 v[16:19], v5, s[8:11], s38 offen offset:0 sc1
    buffer_store_dwordx4 v[20:23], v5, s[8:11], s38 offen offset:1024 sc1
    buffer_store_dwordx4 v[24:27], v5, s[8:11], s38 offen offset:2048 sc1
    buffer_store_dwordx4 v[28:31], v5, s[8:11], s38 offen offset:3072 sc1
    buffer_store_dwordx4 v[32:35], v5, s[8:11], s39 offen offset:0 sc1
    buffer_store_dwordx4 v[36:39], v5, s[8:11], s39 offen offset:1024 sc1
    buffer_store_dwordx4 v[40:43], v5, s[8:11], s39 offen offset:2048 sc1
    buffer_store_dwordx4 v[44:47], v5, s[8:11], s39 offen offset:3072 sc1
    s_barrier
L_prep_done:
    s_waitcnt vmcnt(0) lgkmcnt(0)
    s_barrier
    s_mov_b64 s[4:5], s[48:49]
    s_mov_b32 s6, 256
    s_mov_b32 s7, 0x00020000
    v_mov_b32 v10, 0
    s_mov_b32 s59, 0
L_prep_n2:
    buffer_load_dwordx2 v[12:13], v10, s[4:7], 0 offen sc1
    s_add_u32 s59, s59, 1
    s_waitcnt vmcnt(0)
    v_readfirstlane_b32 s66, v12
    v_readfirstlane_b32 s67, v13
    s_cmp_ge_u32 s59, 0x8000
    s_cbranch_scc1 L_prep_n2_x
    s_cmp_eq_u32 s66, 0
    s_cbranch_scc1 L_prep_n2
    s_sub_u32 s57, s70, s66
    s_cmp_gt_i32 s57, 2000
    s_cbranch_scc1 L_prep_n2
L_prep_n2_x:
    s_cmp_lg_u32 s12, 2
    s_cbranch_scc1 L_prep_nx
    s_getreg_b32 s69, hwreg(HW_REG_XCC_ID, 0, 4)
    s_xor_b32 s69, s69, s67
    s_lshl_b32 s58, s13, 5
    s_add_u32 s58, s58, s14
    s_lshl_b32 s58, s58, 7
    s_add_u32 s58, s58, 0x3e0000
    v_mov_b32 v10, 0
    v_mov_b32 v12, s66
    v_mov_b32 v13, s69
    s_mov_b64 exec, 1
    buffer_store_dwordx2 v[12:13], v10, s[8:11], s58 offen sc1
    s_mov_b64 exec, -1
L_prep_nx:
    s_cmp_lg_u32 s55, 0
    s_cbranch_scc1 L_prep_end
    s_cmp_ge_u32 s52, 94
    s_cbranch_scc1 L_prep_end
    s_lshl_b32 s58, s52, 7
    s_add_u32 s58, s58, 0x300000
    v_mov_b32 v125, 0
    v_mov_b32 v126, s66
    v_mov_b32 v127, s67
    s_mov_b64 exec, 1
    buffer_store_dwordx2 v[126:127], v125, s[8:11], s58 offen sc1
    s_mov_b64 exec, -1
L_prep_end:
    s_branch L_pair_att
L_first_q0:
    s_lshr_b32 s54, s14, 1
    s_and_b32 s55, s12, 3
    s_lshr_b32 s57, s12, 2
    s_lshl_b32 s58, s54, 1
    s_add_u32 s58, s58, s57
    s_mov_b32 s7, 0x00020000
    s_cmp_ge_u32 s58, 16
    s_cbranch_scc1 L_q0_a_kv
    s_mov_b64 s[4:5], s[18:19]
    s_mov_b32 s6, 401408
    s_mov_b32 s32, 896
    s_mul_i32 s33, s58, 56
    s_branch L_q0_a_go
L_q0_a_kv:
    s_mov_b64 s[4:5], s[20:21]
    s_cmp_eq_u32 s58, 16
    s_cbranch_scc1 L_q0_a_kv2
    s_mov_b64 s[4:5], s[22:23]
L_q0_a_kv2:
    s_mov_b32 s6, 25088
    s_mov_b32 s32, 56
    s_mov_b32 s33, 0
L_q0_a_go:
    v_lshrrev_b32 v10, 2, v2
    v_mul_lo_u32 v8, v10, s32
    v_and_b32 v10, 3, v2
    v_lshl_add_u32 v8, v10, 4, v8
    v_add_u32 v8, s33, v8
    s_lshl_b32 s36, s32, 4
    s_mul_i32 s37, s36, 7
    s_mul_i32 s37, s37, s55
    s_mul_i32 s38, s55, 7168
    s_mul_i32 s39, s57, 29696
    s_add_u32 s38, s38, s39
    s_add_u32 s38, s38, 32768
    s_add_u32 m0, s38, 0
    s_nop 0
    buffer_load_dwordx4 v8, s[4:7], s37 offen lds
    s_add_u32 s37, s37, s36
    s_add_u32 m0, s38, 1024
    s_nop 0
    buffer_load_dwordx4 v8, s[4:7], s37 offen lds
    s_add_u32 s37, s37, s36
    s_add_u32 m0, s38, 2048
    s_nop 0
    buffer_load_dwordx4 v8, s[4:7], s37 offen lds
    s_add_u32 s37, s37, s36
    s_add_u32 m0, s38, 3072
    s_nop 0
    buffer_load_dwordx4 v8, s[4:7], s37 offen lds
    s_add_u32 s37, s37, s36
    s_add_u32 m0, s38, 4096
    s_nop 0
    buffer_load_dwordx4 v8, s[4:7], s37 offen lds
    s_add_u32 s37, s37, s36
    s_add_u32 m0, s38, 5120
    s_nop 0
    buffer_load_dwordx4 v8, s[4:7], s37 offen lds
    s_add_u32 s37, s37, s36
    s_add_u32 m0, s38, 6144
    s_nop 0
    buffer_load_dwordx4 v8, s[4:7], s37 offen lds
    s_add_u32 s37, s37, s36
    v_and_b32 v15, 3, v2
    v_lshlrev_b32 v15, 3, v15
    v_bfe_u32 v10, v2, 2, 2
    v_lshl_add_u32 v15, v10, 6, v15
    v_bfe_u32 v10, v2, 4, 1
    v_lshl_add_u32 v15, v10, 5, v15
    v_lshl_add_u32 v15, v4, 8, v15
    v_add_u32 v15, 32768, v15
    s_and_b32 s16, s14, 1
    s_lshl_b32 s15, s13, 1
    s_add_u32 s16, s16, s15
    s_lshr_b32 s17, s14, 1
    s_and_b32 s15, s12, 3
    s_lshl_b32 s18, s16, 2
    s_add_u32 s15, s15, s18
    s_mov_b64 s[4:5], s[48:49]
    s_mov_b32 s6, 256
    s_mov_b32 s7, 0x00020000
    v_mov_b32 v10, 0
    s_mov_b32 s59, 0
L_q0_n:
    buffer_load_dwordx2 v[12:13], v10, s[4:7], 0 offen sc1
    s_add_u32 s59, s59, 1
    s_waitcnt vmcnt(0)
    v_readfirstlane_b32 s66, v12
    v_readfirstlane_b32 s67, v13
    s_cmp_ge_u32 s59, 0x8000
    s_cbranch_scc1 L_q0_n_x
    s_cmp_eq_u32 s66, 0
    s_cbranch_scc1 L_q0_n
    s_sub_u32 s57, s70, s66
    s_cmp_gt_i32 s57, 2000
    s_cbranch_scc1 L_q0_n
L_q0_n_x:
    s_cmp_lg_u32 s12, 7
    s_cbranch_scc1 L_q0_nx
    s_getreg_b32 s69, hwreg(HW_REG_XCC_ID, 0, 4)
    s_xor_b32 s69, s69, s67
    s_lshl_b32 s58, s13, 5
    s_add_u32 s58, s58, s14
    s_lshl_b32 s58, s58, 7
    s_add_u32 s58, s58, 0x3e0000
    v_mov_b32 v10, 0
    v_mov_b32 v12, s66
    v_mov_b32 v13, s69
    s_mov_b64 exec, 1
    buffer_store_dwordx2 v[12:13], v10, s[8:11], s58 offen sc1
    s_mov_b64 exec, -1
L_q0_nx:
    s_waitcnt vmcnt(0)
    s_barrier
    s_cmp_lt_u32 s12, 4
    s_cbranch_scc1 L_q0_wait
    s_cmp_ge_u32 s12, 6
    s_cbranch_scc1 L_q0_wait
    s_sub_u32 s24, s12, 4
    s_mul_i32 s25, s24, 29696
    v_add_u32 v12, s25, v15
    v_mov_b32 v16, 0x3f803f80
    v_mov_b32 v17, 0x3f803f80
    v_mov_b32 v18, 0x3f803f80
    v_mov_b32 v19, 0x3f803f80
    ds_read_b64_tr_b16 v[56:57], v12 offset:0
    ds_read_b64_tr_b16 v[58:59], v12 offset:512
    ds_read_b64_tr_b16 v[60:61], v12 offset:1024
    ds_read_b64_tr_b16 v[62:63], v12 offset:1536
    ds_read_b64_tr_b16 v[64:65], v12 offset:2048
    ds_read_b64_tr_b16 v[66:67], v12 offset:2560
    ds_read_b64_tr_b16 v[68:69], v12 offset:3072
    ds_read_b64_tr_b16 v[70:71], v12 offset:3584
    ds_read_b64_tr_b16 v[72:73], v12 offset:4096
    ds_read_b64_tr_b16 v[74:75], v12 offset:4608
    ds_read_b64_tr_b16 v[76:77], v12 offset:5120
    ds_read_b64_tr_b16 v[78:79], v12 offset:5632
    ds_read_b64_tr_b16 v[80:81], v12 offset:6144
    ds_read_b64_tr_b16 v[82:83], v12 offset:6656
    s_waitcnt lgkmcnt(0)
    ds_read_b64_tr_b16 v[84:85], v12 offset:7168
    ds_read_b64_tr_b16 v[86:87], v12 offset:7680
    ds_read_b64_tr_b16 v[88:89], v12 offset:8192
    ds_read_b64_tr_b16 v[90:91], v12 offset:8704
    ds_read_b64_tr_b16 v[92:93], v12 offset:9216
    ds_read_b64_tr_b16 v[94:95], v12 offset:9728
    ds_read_b64_tr_b16 v[96:97], v12 offset:10240
    ds_read_b64_tr_b16 v[98:99], v12 offset:10752
    ds_read_b64_tr_b16 v[100:101], v12 offset:11264
    ds_read_b64_tr_b16 v[102:103], v12 offset:11776
    ds_read_b64_tr_b16 v[104:105], v12 offset:12288
    ds_read_b64_tr_b16 v[106:107], v12 offset:12800
    ds_read_b64_tr_b16 v[108:109], v12 offset:13312
    ds_read_b64_tr_b16 v[110:111], v12 offset:13824
    s_waitcnt lgkmcnt(0)
    v_mfma_f32_32x32x16_bf16 v[24:39], v[16:19], v[56:59], 0
    v_mfma_f32_32x32x16_bf16 v[24:39], v[16:19], v[60:63], v[24:39]
    v_mfma_f32_32x32x16_bf16 v[24:39], v[16:19], v[64:67], v[24:39]
    v_mfma_f32_32x32x16_bf16 v[24:39], v[16:19], v[68:71], v[24:39]
    v_mfma_f32_32x32x16_bf16 v[24:39], v[16:19], v[72:75], v[24:39]
    v_mfma_f32_32x32x16_bf16 v[24:39], v[16:19], v[76:79], v[24:39]
    v_mfma_f32_32x32x16_bf16 v[24:39], v[16:19], v[80:83], v[24:39]
    v_mfma_f32_32x32x16_bf16 v[24:39], v[16:19], v[84:87], v[24:39]
    v_mfma_f32_32x32x16_bf16 v[24:39], v[16:19], v[88:91], v[24:39]
    v_mfma_f32_32x32x16_bf16 v[24:39], v[16:19], v[92:95], v[24:39]
    v_mfma_f32_32x32x16_bf16 v[24:39], v[16:19], v[96:99], v[24:39]
    v_mfma_f32_32x32x16_bf16 v[24:39], v[16:19], v[100:103], v[24:39]
    v_mfma_f32_32x32x16_bf16 v[24:39], v[16:19], v[104:107], v[24:39]
    v_mfma_f32_32x32x16_bf16 v[24:39], v[16:19], v[108:111], v[24:39]
    ds_read_b64_tr_b16 v[56:57], v12 offset:14336
    ds_read_b64_tr_b16 v[58:59], v12 offset:14848
    ds_read_b64_tr_b16 v[60:61], v12 offset:15360
    ds_read_b64_tr_b16 v[62:63], v12 offset:15872
    ds_read_b64_tr_b16 v[64:65], v12 offset:16384
    ds_read_b64_tr_b16 v[66:67], v12 offset:16896
    ds_read_b64_tr_b16 v[68:69], v12 offset:17408
    ds_read_b64_tr_b16 v[70:71], v12 offset:17920
    ds_read_b64_tr_b16 v[72:73], v12 offset:18432
    ds_read_b64_tr_b16 v[74:75], v12 offset:18944
    ds_read_b64_tr_b16 v[76:77], v12 offset:19456
    ds_read_b64_tr_b16 v[78:79], v12 offset:19968
    ds_read_b64_tr_b16 v[80:81], v12 offset:20480
    ds_read_b64_tr_b16 v[82:83], v12 offset:20992
    s_waitcnt lgkmcnt(0)
    ds_read_b64_tr_b16 v[84:85], v12 offset:21504
    ds_read_b64_tr_b16 v[86:87], v12 offset:22016
    ds_read_b64_tr_b16 v[88:89], v12 offset:22528
    ds_read_b64_tr_b16 v[90:91], v12 offset:23040
    ds_read_b64_tr_b16 v[92:93], v12 offset:23552
    ds_read_b64_tr_b16 v[94:95], v12 offset:24064
    ds_read_b64_tr_b16 v[96:97], v12 offset:24576
    ds_read_b64_tr_b16 v[98:99], v12 offset:25088
    ds_read_b64_tr_b16 v[100:101], v12 offset:25600
    ds_read_b64_tr_b16 v[102:103], v12 offset:26112
    ds_read_b64_tr_b16 v[104:105], v12 offset:26624
    ds_read_b64_tr_b16 v[106:107], v12 offset:27136
    ds_read_b64_tr_b16 v[108:109], v12 offset:27648
    ds_read_b64_tr_b16 v[110:111], v12 offset:28160
    s_waitcnt lgkmcnt(0)
    v_mfma_f32_32x32x16_bf16 v[24:39], v[16:19], v[56:59], v[24:39]
    v_mfma_f32_32x32x16_bf16 v[24:39], v[16:19], v[60:63], v[24:39]
    v_mfma_f32_32x32x16_bf16 v[24:39], v[16:19], v[64:67], v[24:39]
    v_mfma_f32_32x32x16_bf16 v[24:39], v[16:19], v[68:71], v[24:39]
    v_mfma_f32_32x32x16_bf16 v[24:39], v[16:19], v[72:75], v[24:39]
    v_mfma_f32_32x32x16_bf16 v[24:39], v[16:19], v[76:79], v[24:39]
    v_mfma_f32_32x32x16_bf16 v[24:39], v[16:19], v[80:83], v[24:39]
    v_mfma_f32_32x32x16_bf16 v[24:39], v[16:19], v[84:87], v[24:39]
    v_mfma_f32_32x32x16_bf16 v[24:39], v[16:19], v[88:91], v[24:39]
    v_mfma_f32_32x32x16_bf16 v[24:39], v[16:19], v[92:95], v[24:39]
    v_mfma_f32_32x32x16_bf16 v[24:39], v[16:19], v[96:99], v[24:39]
    v_mfma_f32_32x32x16_bf16 v[24:39], v[16:19], v[100:103], v[24:39]
    v_mfma_f32_32x32x16_bf16 v[24:39], v[16:19], v[104:107], v[24:39]
    v_mfma_f32_32x32x16_bf16 v[24:39], v[16:19], v[108:111], v[24:39]
    s_add_u32 s25, s25, 61440
    v_lshl_add_u32 v10, v3, 2, s25
    s_nop 9
    ds_write_b32 v10, v24
    s_waitcnt lgkmcnt(0)
L_q0_wait:
    s_lshl_b32 s19, s16, 4
    s_add_u32 s19, s19, 96
    s_cmp_lg_u32 s12, 0
    s_cbranch_scc1 Lwq0_mega_1_skip
    v_min_u32 v11, 15, v2
    v_lshlrev_b32 v11, 7, v11
    s_lshl_b32 s58, s19, 7
    s_add_u32 s58, s58, s61
    s_add_u32 s58, s58, 0xffff0000
    s_mov_b32 s59, 0
Lwq0_mega_1:
    buffer_load_dwordx2 v[12:13], v11, s[8:11], s58 offen sc1
    s_add_u32 s59, s59, 1
    s_waitcnt vmcnt(0)
    v_cmp_ne_u64 vcc, s[66:67], v[12:13]
    s_cmp_ge_u32 s59, 0x8000
    s_cbranch_scc1 Lwq0_mega_1_t
    s_nop 0
    s_cbranch_vccnz Lwq0_mega_1
Lwq0_mega_1_t:
Lwq0_mega_1_skip:
    s_waitcnt vmcnt(0)
    s_barrier
    s_branch L_qkvA_tr
L_pair:
    s_and_b32 s16, s14, 1
    s_lshl_b32 s15, s13, 1
    s_add_u32 s16, s16, s15
    s_lshr_b32 s17, s14, 1
    s_and_b32 s15, s12, 3
    s_lshl_b32 s18, s16, 2
    s_add_u32 s15, s15, s18
    s_cmp_ge_u32 s17, 9
    s_cbranch_scc1 L_qkvA_end
    s_lshl_b32 s19, s16, 4
    s_cmp_lg_u32 s12, 0
    s_cbranch_scc1 Lwqa_mega_2_skip
    v_min_u32 v11, 13, v2
    v_lshlrev_b32 v11, 7, v11
    s_lshl_b32 s58, s19, 7
    s_add_u32 s58, s58, s61
    s_add_u32 s58, s58, 0xffff0000
    s_mov_b32 s59, 0
Lwqa_mega_2:
    buffer_load_dwordx2 v[12:13], v11, s[8:11], s58 offen sc1
    s_add_u32 s59, s59, 1
    s_waitcnt vmcnt(0)
    v_cmp_ne_u64 vcc, s[66:67], v[12:13]
    s_cmp_ge_u32 s59, 0x8000
    s_cbranch_scc1 Lwqa_mega_2_t
    s_nop 0
    s_cbranch_vccnz Lwqa_mega_2
Lwqa_mega_2_t:
Lwqa_mega_2_skip:
    s_waitcnt vmcnt(0)
    s_barrier
    s_cmp_ge_u32 s12, 4
    s_cbranch_scc1 L_qkvA_sig
    s_mul_i32 s20, s15, 28672
    s_add_u32 s20, s20, s60
    s_cmp_eq_u32 s17, 8
    s_cbranch_scc1 L_qkvA_kv
    s_lshl_b32 s32, s15, 4
    s_lshl_b32 s33, s17, 1
    s_add_u32 s32, s32, s33
    s_lshl_b32 s32, s32, 11
    s_add_u32 s32, s32, s60
    s_add_u32 s32, s32, 0x200000
    s_add_u32 s33, s32, 2048
    s_add_u32 s25, s20, 0
    buffer_load_dwordx4 a[0:3], v5, s[8:11], s25 offen offset:0 sc1
    buffer_load_dwordx4 a[4:7], v5, s[8:11], s25 offen offset:1024 sc1
    buffer_load_dwordx4 a[8:11], v5, s[8:11], s25 offen offset:2048 sc1
    buffer_load_dwordx4 a[12:15], v5, s[8:11], s25 offen offset:3072 sc1
    v_lshlrev_b32 v10, 4, v3
    v_lshl_add_u32 v10, v4, 11, v10
    s_lshl_b32 s27, s15, 12
    s_add_u32 s27, s27, s60
    s_add_u32 s27, s27, 0x1c0000
    buffer_load_dwordx4 v[72:75], v10, s[8:11], s27 offen offset:0 sc1
    buffer_load_dwordx4 v[76:79], v10, s[8:11], s27 offen offset:512 sc1
    buffer_load_dwordx4 v[80:83], v10, s[8:11], s27 offen offset:1024 sc1
    buffer_load_dwordx4 v[84:87], v10, s[8:11], s27 offen offset:1536 sc1
    v_lshlrev_b32 v11, 4, v4
    v_add_u32 v11, 61440, v11
    ds_read_b128 v[88:91], v11 offset:0
    ds_read_b128 v[92:95], v11 offset:32
    ds_read_b128 v[96:99], v11 offset:64
    ds_read_b128 v[100:103], v11 offset:96
    v_lshlrev_b32 v11, 4, v4
    v_add_u32 v11, 91136, v11
    ds_read_b128 v[104:107], v11 offset:0
    ds_read_b128 v[108:111], v11 offset:32
    ds_read_b128 v[112:115], v11 offset:64
    ds_read_b128 v[116:119], v11 offset:96
    s_add_u32 s25, s20, 4096
    buffer_load_dwordx4 a[16:19], v5, s[8:11], s25 offen offset:0 sc1
    buffer_load_dwordx4 a[20:23], v5, s[8:11], s25 offen offset:1024 sc1
    buffer_load_dwordx4 a[24:27], v5, s[8:11], s25 offen offset:2048 sc1
    buffer_load_dwordx4 a[28:31], v5, s[8:11], s25 offen offset:3072 sc1
    ds_read_b128 v[16:19], v5 offset:32768
    ds_read_b128 v[20:23], v5 offset:62464
    ds_read_b128 v[24:27], v5 offset:33792
    ds_read_b128 v[28:31], v5 offset:63488
    ds_read_b128 v[32:35], v5 offset:34816
    s_waitcnt vmcnt(8)
    ds_read_b128 v[36:39], v5 offset:64512
    s_waitcnt lgkmcnt(5)
    v_mfma_f32_32x32x16_bf16 v[40:55], v[16:19], a[0:3], 0
    s_add_u32 s25, s20, 8192
    buffer_load_dwordx4 a[32:35], v5, s[8:11], s25 offen offset:0 sc1
    ds_read_b128 v[16:19], v5 offset:35840
    s_waitcnt lgkmcnt(5)
    v_mfma_f32_32x32x16_bf16 v[56:71], v[20:23], a[0:3], 0
    ds_read_b128 v[20:23], v6 offset:0
    s_waitcnt lgkmcnt(5)
    v_mfma_f32_32x32x16_bf16 v[40:55], v[24:27], a[4:7], v[40:55]
    buffer_load_dwordx4 a[36:39], v5, s[8:11], s25 offen offset:1024 sc1
    ds_read_b128 v[24:27], v5 offset:36864
    s_waitcnt lgkmcnt(5)
    v_mfma_f32_32x32x16_bf16 v[56:71], v[28:31], a[4:7], v[56:71]
    ds_read_b128 v[28:31], v6 offset:1024
    s_waitcnt lgkmcnt(5)
    v_mfma_f32_32x32x16_bf16 v[40:55], v[32:35], a[8:11], v[40:55]
    buffer_load_dwordx4 a[40:43], v5, s[8:11], s25 offen offset:2048 sc1
    ds_read_b128 v[32:35], v5 offset:37888
    s_waitcnt lgkmcnt(5)
    v_mfma_f32_32x32x16_bf16 v[56:71], v[36:39], a[8:11], v[56:71]
    ds_read_b128 v[36:39], v6 offset:2048
    s_waitcnt lgkmcnt(5)
    v_mfma_f32_32x32x16_bf16 v[40:55], v[16:19], a[12:15], v[40:55]
    buffer_load_dwordx4 a[44:47], v5, s[8:11], s25 offen offset:3072 sc1
    ds_read_b128 v[16:19], v5 offset:38912
    s_waitcnt lgkmcnt(5)
    v_mfma_f32_32x32x16_bf16 v[56:71], v[20:23], a[12:15], v[56:71]
    s_waitcnt vmcnt(4)
    ds_read_b128 v[20:23], v6 offset:3072
    s_waitcnt lgkmcnt(5)
    v_mfma_f32_32x32x16_bf16 v[40:55], v[24:27], a[16:19], v[40:55]
    s_add_u32 s25, s20, 12288
    buffer_load_dwordx4 a[48:51], v5, s[8:11], s25 offen offset:0 sc1
    v_cmp_eq_u32 vcc, 0, v4
    s_nop 1
    v_cndmask_b32 v12, 0, -1, vcc
    v_and_b32 v84, v84, v12
    v_and_b32 v85, v85, v12
    v_and_b32 v86, v86, v12
    v_and_b32 v87, v87, v12
    v_add_f32 v72, v72, v74
    v_add_f32 v73, v73, v75
    v_add_f32 v72, v72, v76
    v_add_f32 v73, v73, v77
    v_add_f32 v72, v72, v78
    v_add_f32 v73, v73, v79
    v_add_f32 v72, v72, v80
    v_add_f32 v73, v73, v81
    v_add_f32 v72, v72, v82
    v_add_f32 v73, v73, v83
    v_add_f32 v72, v72, v84
    v_add_f32 v73, v73, v85
    v_add_f32 v72, v72, v86
    v_add_f32 v73, v73, v87
    v_mov_b32 v74, v72
    v_mov_b32 v75, v73
    s_nop 0
    v_permlane32_swap_b32 v72, v74
    v_permlane32_swap_b32 v73, v75
    v_add_f32 v72, v72, v74
    v_add_f32 v73, v73, v75
    v_mul_f32 v8, 0xbb124925, v72
    v_mul_f32 v10, 0x3b124925, v73
    v_fma_f32 v10, -v8, v8, v10
    v_max_f32 v10, 0, v10
    v_add_f32 v10, 0x3727c5ac, v10
    v_rsq_f32 v9, v10
    s_nop 0
    v_mul_f32 v14, 0x3e8b97f6, v9
    ds_read_b128 v[24:27], v5 offset:39936
    s_waitcnt lgkmcnt(5)
    v_mfma_f32_32x32x16_bf16 v[56:71], v[28:31], a[16:19], v[56:71]
    ds_read_b128 v[28:31], v6 offset:4096
    s_waitcnt lgkmcnt(5)
    v_mfma_f32_32x32x16_bf16 v[40:55], v[32:35], a[20:23], v[40:55]
    buffer_load_dwordx4 a[52:55], v5, s[8:11], s25 offen offset:1024 sc1
    ds_read_b128 v[32:35], v5 offset:40960
    s_waitcnt lgkmcnt(5)
    v_mfma_f32_32x32x16_bf16 v[56:71], v[36:39], a[20:23], v[56:71]
    ds_read_b128 v[36:39], v6 offset:5120
    s_waitcnt lgkmcnt(5)
    v_mfma_f32_32x32x16_bf16 v[40:55], v[16:19], a[24:27], v[40:55]
    buffer_load_dwordx4 a[56:59], v5, s[8:11], s25 offen offset:2048 sc1
    ds_read_b128 v[16:19], v5 offset:41984
    s_waitcnt lgkmcnt(5)
    v_mfma_f32_32x32x16_bf16 v[56:71], v[20:23], a[24:27], v[56:71]
    ds_read_b128 v[20:23], v6 offset:6144
    s_waitcnt lgkmcnt(5)
    v_mfma_f32_32x32x16_bf16 v[40:55], v[24:27], a[28:31], v[40:55]
    buffer_load_dwordx4 a[60:63], v5, s[8:11], s25 offen offset:3072 sc1
    ds_read_b128 v[24:27], v5 offset:43008
    s_waitcnt lgkmcnt(5)
    v_mfma_f32_32x32x16_bf16 v[56:71], v[28:31], a[28:31], v[56:71]
    s_waitcnt vmcnt(4)
    ds_read_b128 v[28:31], v6 offset:7168
    s_waitcnt lgkmcnt(5)
    v_mfma_f32_32x32x16_bf16 v[40:55], v[32:35], a[32:35], v[40:55]
    s_add_u32 s25, s20, 16384
    buffer_load_dwordx4 a[64:67], v5, s[8:11], s25 offen offset:0 sc1
    ds_read_b128 v[32:35], v5 offset:44032
    s_waitcnt lgkmcnt(5)
    v_mfma_f32_32x32x16_bf16 v[56:71], v[36:39], a[32:35], v[56:71]
    ds_read_b128 v[36:39], v6 offset:8192
    s_waitcnt lgkmcnt(5)
    v_mfma_f32_32x32x16_bf16 v[40:55], v[16:19], a[36:39], v[40:55]
    buffer_load_dwordx4 a[68:71], v5, s[8:11], s25 offen offset:1024 sc1
    ds_read_b128 v[16:19], v5 offset:45056
    s_waitcnt lgkmcnt(5)
    v_mfma_f32_32x32x16_bf16 v[56:71], v[20:23], a[36:39], v[56:71]
    ds_read_b128 v[20:23], v6 offset:9216
    s_waitcnt lgkmcnt(5)
    v_mfma_f32_32x32x16_bf16 v[40:55], v[24:27], a[40:43], v[40:55]
    buffer_load_dwordx4 a[72:75], v5, s[8:11], s25 offen offset:2048 sc1
    ds_read_b128 v[24:27], v5 offset:46080
    s_waitcnt lgkmcnt(5)
    v_mfma_f32_32x32x16_bf16 v[56:71], v[28:31], a[40:43], v[56:71]
    ds_read_b128 v[28:31], v6 offset:10240
    s_waitcnt lgkmcnt(5)
    v_mfma_f32_32x32x16_bf16 v[40:55], v[32:35], a[44:47], v[40:55]
    buffer_load_dwordx4 a[76:79], v5, s[8:11], s25 offen offset:3072 sc1
    ds_read_b128 v[32:35], v5 offset:47104
    s_waitcnt lgkmcnt(5)
    v_mfma_f32_32x32x16_bf16 v[56:71], v[36:39], a[44:47], v[56:71]
    s_waitcnt vmcnt(4)
    ds_read_b128 v[36:39], v6 offset:11264
    s_waitcnt lgkmcnt(5)
    v_mfma_f32_32x32x16_bf16 v[40:55], v[16:19], a[48:51], v[40:55]
    s_add_u32 s25, s20, 20480
    buffer_load_dwordx4 a[80:83], v5, s[8:11], s25 offen offset:0 sc1
    ds_read_b128 v[16:19], v5 offset:48128
    s_waitcnt lgkmcnt(5)
    v_mfma_f32_32x32x16_bf16 v[56:71], v[20:23], a[48:51], v[56:71]
    ds_read_b128 v[20:23], v6 offset:12288
    s_waitcnt lgkmcnt(5)
    v_mfma_f32_32x32x16_bf16 v[40:55], v[24:27], a[52:55], v[40:55]
    buffer_load_dwordx4 a[84:87], v5, s[8:11], s25 offen offset:1024 sc1
    ds_read_b128 v[24:27], v5 offset:49152
    s_waitcnt lgkmcnt(5)
    v_mfma_f32_32x32x16_bf16 v[56:71], v[28:31], a[52:55], v[56:71]
    ds_read_b128 v[28:31], v6 offset:13312
    s_waitcnt lgkmcnt(5)
    v_mfma_f32_32x32x16_bf16 v[40:55], v[32:35], a[56:59], v[40:55]
    buffer_load_dwordx4 a[88:91], v5, s[8:11], s25 offen offset:2048 sc1
    ds_read_b128 v[32:35], v5 offset:50176
    s_waitcnt lgkmcnt(5)
    v_mfma_f32_32x32x16_bf16 v[56:71], v[36:39], a[56:59], v[56:71]
    ds_read_b128 v[36:39], v6 offset:14336
    s_waitcnt lgkmcnt(5)
    v_mfma_f32_32x32x16_bf16 v[40:55], v[16:19], a[60:63], v[40:55]
    buffer_load_dwordx4 a[92:95], v5, s[8:11], s25 offen offset:3072 sc1
    ds_read_b128 v[16:19], v5 offset:51200
    s_waitcnt lgkmcnt(5)
    v_mfma_f32_32x32x16_bf16 v[56:71], v[20:23], a[60:63], v[56:71]
    s_waitcnt vmcnt(4)
    ds_read_b128 v[20:23], v6 offset:15360
    s_waitcnt lgkmcnt(5)
    v_mfma_f32_32x32x16_bf16 v[40:55], v[24:27], a[64:67], v[40:55]
    s_add_u32 s25, s20, 24576
    buffer_load_dwordx4 a[96:99], v5, s[8:11], s25 offen offset:0 sc1
    ds_read_b128 v[24:27], v5 offset:52224
    s_waitcnt lgkmcnt(5)
    v_mfma_f32_32x32x16_bf16 v[56:71], v[28:31], a[64:67], v[56:71]
    ds_read_b128 v[28:31], v6 offset:16384
    s_waitcnt lgkmcnt(5)
    v_mfma_f32_32x32x16_bf16 v[40:55], v[32:35], a[68:71], v[40:55]
    buffer_load_dwordx4 a[100:103], v5, s[8:11], s25 offen offset:1024 sc1
    ds_read_b128 v[32:35], v5 offset:53248
    s_waitcnt lgkmcnt(5)
    v_mfma_f32_32x32x16_bf16 v[56:71], v[36:39], a[68:71], v[56:71]
    ds_read_b128 v[36:39], v6 offset:17408
    s_waitcnt lgkmcnt(5)
    v_mfma_f32_32x32x16_bf16 v[40:55], v[16:19], a[72:75], v[40:55]
    buffer_load_dwordx4 a[104:107], v5, s[8:11], s25 offen offset:2048 sc1
    ds_read_b128 v[16:19], v5 offset:54272
    s_waitcnt lgkmcnt(5)
    v_mfma_f32_32x32x16_bf16 v[56:71], v[20:23], a[72:75], v[56:71]
    ds_read_b128 v[20:23], v6 offset:18432
    s_waitcnt lgkmcnt(5)
    v_mfma_f32_32x32x16_bf16 v[40:55], v[24:27], a[76:79], v[40:55]
    buffer_load_dwordx4 a[108:111], v5, s[8:11], s25 offen offset:3072 sc1
    ds_read_b128 v[24:27], v5 offset:55296
    s_waitcnt lgkmcnt(5)
    v_mfma_f32_32x32x16_bf16 v[56:71], v[28:31], a[76:79], v[56:71]
    s_waitcnt vmcnt(4)
    ds_read_b128 v[28:31], v6 offset:19456
    s_waitcnt lgkmcnt(5)
    v_mfma_f32_32x32x16_bf16 v[40:55], v[32:35], a[80:83], v[40:55]
    ds_read_b128 v[32:35], v5 offset:56320
    s_waitcnt lgkmcnt(5)
    v_mfma_f32_32x32x16_bf16 v[56:71], v[36:39], a[80:83], v[56:71]
    ds_read_b128 v[36:39], v6 offset:20480
    s_waitcnt lgkmcnt(5)
    v_mfma_f32_32x32x16_bf16 v[40:55], v[16:19], a[84:87], v[40:55]
    ds_read_b128 v[16:19], v5 offset:57344
    s_waitcnt lgkmcnt(5)
    v_mfma_f32_32x32x16_bf16 v[56:71], v[20:23], a[84:87], v[56:71]
    ds_read_b128 v[20:23], v6 offset:21504
    s_waitcnt lgkmcnt(5)
    v_mfma_f32_32x32x16_bf16 v[40:55], v[24:27], a[88:91], v[40:55]
    ds_read_b128 v[24:27], v5 offset:58368
    s_waitcnt lgkmcnt(5)
    v_mfma_f32_32x32x16_bf16 v[56:71], v[28:31], a[88:91], v[56:71]
    ds_read_b128 v[28:31], v6 offset:22528
    s_waitcnt lgkmcnt(5)
    v_mfma_f32_32x32x16_bf16 v[40:55], v[32:35], a[92:95], v[40:55]
    ds_read_b128 v[32:35], v5 offset:59392
    s_waitcnt lgkmcnt(5)
    v_mfma_f32_32x32x16_bf16 v[56:71], v[36:39], a[92:95], v[56:71]
    s_waitcnt vmcnt(0)
    ds_read_b128 v[36:39], v6 offset:23552
    s_waitcnt lgkmcnt(5)
    v_mfma_f32_32x32x16_bf16 v[40:55], v[16:19], a[96:99], v[40:55]
    ds_read_b128 v[16:19], v5 offset:60416
    s_waitcnt lgkmcnt(5)
    v_mfma_f32_32x32x16_bf16 v[56:71], v[20:23], a[96:99], v[56:71]
    ds_read_b128 v[20:23], v6 offset:24576
    s_waitcnt lgkmcnt(5)
    v_mfma_f32_32x32x16_bf16 v[40:55], v[24:27], a[100:103], v[40:55]
    s_waitcnt lgkmcnt(4)
    v_mfma_f32_32x32x16_bf16 v[56:71], v[28:31], a[100:103], v[56:71]
    s_waitcnt lgkmcnt(3)
    v_mfma_f32_32x32x16_bf16 v[40:55], v[32:35], a[104:107], v[40:55]
    s_waitcnt lgkmcnt(2)
    v_mfma_f32_32x32x16_bf16 v[56:71], v[36:39], a[104:107], v[56:71]
    s_waitcnt lgkmcnt(1)
    v_mfma_f32_32x32x16_bf16 v[40:55], v[16:19], a[108:111], v[40:55]
    s_waitcnt lgkmcnt(0)
    v_mfma_f32_32x32x16_bf16 v[56:71], v[20:23], a[108:111], v[56:71]
    s_branch L_qkvA_epiTT
L_qkvA_kv:
    s_lshl_b32 s32, s15, 12
    s_add_u32 s32, s32, s60
    s_add_u32 s32, s32, 0xa00000
    s_lshl_b32 s33, s62, 19
    s_add_u32 s32, s32, s33
    s_add_u32 s33, s32, 2048
    s_add_u32 s25, s20, 0
    buffer_load_dwordx4 a[0:3], v5, s[8:11], s25 offen offset:0 sc1
    buffer_load_dwordx4 a[4:7], v5, s[8:11], s25 offen offset:1024 sc1
    buffer_load_dwordx4 a[8:11], v5, s[8:11], s25 offen offset:2048 sc1
    buffer_load_dwordx4 a[12:15], v5, s[8:11], s25 offen offset:3072 sc1
    v_lshlrev_b32 v10, 4, v3
    v_lshl_add_u32 v10, v4, 11, v10
    s_lshl_b32 s27, s15, 12
    s_add_u32 s27, s27, s60
    s_add_u32 s27, s27, 0x1c0000
    buffer_load_dwordx4 v[72:75], v10, s[8:11], s27 offen offset:0 sc1
    buffer_load_dwordx4 v[76:79], v10, s[8:11], s27 offen offset:512 sc1
    buffer_load_dwordx4 v[80:83], v10, s[8:11], s27 offen offset:1024 sc1
    buffer_load_dwordx4 v[84:87], v10, s[8:11], s27 offen offset:1536 sc1
    v_lshlrev_b32 v11, 4, v4
    v_add_u32 v11, 61440, v11
    ds_read_b128 v[88:91], v11 offset:0
    ds_read_b128 v[92:95], v11 offset:32
    ds_read_b128 v[96:99], v11 offset:64
    ds_read_b128 v[100:103], v11 offset:96
    v_lshlrev_b32 v11, 2, v3
    v_add_u32 v11, 91136, v11
    ds_read_b32 v104, v11
    s_add_u32 s25, s20, 4096
    buffer_load_dwordx4 a[16:19], v5, s[8:11], s25 offen offset:0 sc1
    buffer_load_dwordx4 a[20:23], v5, s[8:11], s25 offen offset:1024 sc1
    buffer_load_dwordx4 a[24:27], v5, s[8:11], s25 offen offset:2048 sc1
    buffer_load_dwordx4 a[28:31], v5, s[8:11], s25 offen offset:3072 sc1
    ds_read_b128 v[16:19], v5 offset:32768
    ds_read_b128 v[20:23], v5 offset:62464
    ds_read_b128 v[24:27], v5 offset:33792
    ds_read_b128 v[28:31], v5 offset:63488
    ds_read_b128 v[32:35], v5 offset:34816
    s_waitcnt vmcnt(8)
    ds_read_b128 v[36:39], v5 offset:64512
    s_waitcnt lgkmcnt(5)
    v_mfma_f32_32x32x16_bf16 v[40:55], v[16:19], a[0:3], 0
    s_add_u32 s25, s20, 8192
    buffer_load_dwordx4 a[32:35], v5, s[8:11], s25 offen offset:0 sc1
    ds_read_b128 v[16:19], v5 offset:35840
    s_waitcnt lgkmcnt(5)
    v_mfma_f32_32x32x16_bf16 v[56:71], a[0:3], v[20:23], 0
    ds_read_b128 v[20:23], v6 offset:0
    s_waitcnt lgkmcnt(5)
    v_mfma_f32_32x32x16_bf16 v[40:55], v[24:27], a[4:7], v[40:55]
    buffer_load_dwordx4 a[36:39], v5, s[8:11], s25 offen offset:1024 sc1
    ds_read_b128 v[24:27], v5 offset:36864
    s_waitcnt lgkmcnt(5)
    v_mfma_f32_32x32x16_bf16 v[56:71], a[4:7], v[28:31], v[56:71]
    ds_read_b128 v[28:31], v6 offset:1024
    s_waitcnt lgkmcnt(5)
    v_mfma_f32_32x32x16_bf16 v[40:55], v[32:35], a[8:11], v[40:55]
    buffer_load_dwordx4 a[40:43], v5, s[8:11], s25 offen offset:2048 sc1
    ds_read_b128 v[32:35], v5 offset:37888
    s_waitcnt lgkmcnt(5)
    v_mfma_f32_32x32x16_bf16 v[56:71], a[8:11], v[36:39], v[56:71]
    ds_read_b128 v[36:39], v6 offset:2048
    s_waitcnt lgkmcnt(5)
    v_mfma_f32_32x32x16_bf16 v[40:55], v[16:19], a[12:15], v[40:55]
    buffer_load_dwordx4 a[44:47], v5, s[8:11], s25 offen offset:3072 sc1
    ds_read_b128 v[16:19], v5 offset:38912
    s_waitcnt lgkmcnt(5)
    v_mfma_f32_32x32x16_bf16 v[56:71], a[12:15], v[20:23], v[56:71]
    s_waitcnt vmcnt(4)
    ds_read_b128 v[20:23], v6 offset:3072
    s_waitcnt lgkmcnt(5)
    v_mfma_f32_32x32x16_bf16 v[40:55], v[24:27], a[16:19], v[40:55]
    s_add_u32 s25, s20, 12288
    buffer_load_dwordx4 a[48:51], v5, s[8:11], s25 offen offset:0 sc1
    v_cmp_eq_u32 vcc, 0, v4
    s_nop 1
    v_cndmask_b32 v12, 0, -1, vcc
    v_and_b32 v84, v84, v12
    v_and_b32 v85, v85, v12
    v_and_b32 v86, v86, v12
    v_and_b32 v87, v87, v12
    v_add_f32 v72, v72, v74
    v_add_f32 v73, v73, v75
    v_add_f32 v72, v72, v76
    v_add_f32 v73, v73, v77
    v_add_f32 v72, v72, v78
    v_add_f32 v73, v73, v79
    v_add_f32 v72, v72, v80
    v_add_f32 v73, v73, v81
    v_add_f32 v72, v72, v82
    v_add_f32 v73, v73, v83
    v_add_f32 v72, v72, v84
    v_add_f32 v73, v73, v85
    v_add_f32 v72, v72, v86
    v_add_f32 v73, v73, v87
    v_mov_b32 v74, v72
    v_mov_b32 v75, v73
    s_nop 0
    v_permlane32_swap_b32 v72, v74
    v_permlane32_swap_b32 v73, v75
    v_add_f32 v72, v72, v74
    v_add_f32 v73, v73, v75
    v_mul_f32 v8, 0xbb124925, v72
    v_mul_f32 v10, 0x3b124925, v73
    v_fma_f32 v10, -v8, v8, v10
    v_max_f32 v10, 0, v10
    v_add_f32 v10, 0x3727c5ac, v10
    v_rsq_f32 v9, v10
    s_nop 0
    v_mul_f32 v14, 0x3e8b97f6, v9
    ds_read_b128 v[24:27], v5 offset:39936
    s_waitcnt lgkmcnt(5)
    v_mfma_f32_32x32x16_bf16 v[56:71], a[16:19], v[28:31], v[56:71]
    ds_read_b128 v[28:31], v6 offset:4096
    s_waitcnt lgkmcnt(5)
    v_mfma_f32_32x32x16_bf16 v[40:55], v[32:35], a[20:23], v[40:55]
    buffer_load_dwordx4 a[52:55], v5, s[8:11], s25 offen offset:1024 sc1
    ds_read_b128 v[32:35], v5 offset:40960
    s_waitcnt lgkmcnt(5)
    v_mfma_f32_32x32x16_bf16 v[56:71], a[20:23], v[36:39], v[56:71]
    ds_read_b128 v[36:39], v6 offset:5120
    s_waitcnt lgkmcnt(5)
    v_mfma_f32_32x32x16_bf16 v[40:55], v[16:19], a[24:27], v[40:55]
    buffer_load_dwordx4 a[56:59], v5, s[8:11], s25 offen offset:2048 sc1
    ds_read_b128 v[16:19], v5 offset:41984
    s_waitcnt lgkmcnt(5)
    v_mfma_f32_32x32x16_bf16 v[56:71], a[24:27], v[20:23], v[56:71]
    ds_read_b128 v[20:23], v6 offset:6144
    s_waitcnt lgkmcnt(5)
    v_mfma_f32_32x32x16_bf16 v[40:55], v[24:27], a[28:31], v[40:55]
    buffer_load_dwordx4 a[60:63], v5, s[8:11], s25 offen offset:3072 sc1
    ds_read_b128 v[24:27], v5 offset:43008
    s_waitcnt lgkmcnt(5)
    v_mfma_f32_32x32x16_bf16 v[56:71], a[28:31], v[28:31], v[56:71]
    s_waitcnt vmcnt(4)
    ds_read_b128 v[28:31], v6 offset:7168
    s_waitcnt lgkmcnt(5)
    v_mfma_f32_32x32x16_bf16 v[40:55], v[32:35], a[32:35], v[40:55]
    s_add_u32 s25, s20, 16384
    buffer_load_dwordx4 a[64:67], v5, s[8:11], s25 offen offset:0 sc1
    ds_read_b128 v[32:35], v5 offset:44032
    s_waitcnt lgkmcnt(5)
    v_mfma_f32_32x32x16_bf16 v[56:71], a[32:35], v[36:39], v[56:71]
    ds_read_b128 v[36:39], v6 offset:8192
    s_waitcnt lgkmcnt(5)
    v_mfma_f32_32x32x16_bf16 v[40:55], v[16:19], a[36:39], v[40:55]
    buffer_load_dwordx4 a[68:71], v5, s[8:11], s25 offen offset:1024 sc1
    ds_read_b128 v[16:19], v5 offset:45056
    s_waitcnt lgkmcnt(5)
    v_mfma_f32_32x32x16_bf16 v[56:71], a[36:39], v[20:23], v[56:71]
    ds_read_b128 v[20:23], v6 offset:9216
    s_waitcnt lgkmcnt(5)
    v_mfma_f32_32x32x16_bf16 v[40:55], v[24:27], a[40:43], v[40:55]
    buffer_load_dwordx4 a[72:75], v5, s[8:11], s25 offen offset:2048 sc1
    ds_read_b128 v[24:27], v5 offset:46080
    s_waitcnt lgkmcnt(5)
    v_mfma_f32_32x32x16_bf16 v[56:71], a[40:43], v[28:31], v[56:71]
    ds_read_b128 v[28:31], v6 offset:10240
    s_waitcnt lgkmcnt(5)
    v_mfma_f32_32x32x16_bf16 v[40:55], v[32:35], a[44:47], v[40:55]
    buffer_load_dwordx4 a[76:79], v5, s[8:11], s25 offen offset:3072 sc1
    ds_read_b128 v[32:35], v5 offset:47104
    s_waitcnt lgkmcnt(5)
    v_mfma_f32_32x32x16_bf16 v[56:71], a[44:47], v[36:39], v[56:71]
    s_waitcnt vmcnt(4)
    ds_read_b128 v[36:39], v6 offset:11264
    s_waitcnt lgkmcnt(5)
    v_mfma_f32_32x32x16_bf16 v[40:55], v[16:19], a[48:51], v[40:55]
    s_add_u32 s25, s20, 20480
    buffer_load_dwordx4 a[80:83], v5, s[8:11], s25 offen offset:0 sc1
    ds_read_b128 v[16:19], v5 offset:48128
    s_waitcnt lgkmcnt(5)
    v_mfma_f32_32x32x16_bf16 v[56:71], a[48:51], v[20:23], v[56:71]
    ds_read_b128 v[20:23], v6 offset:12288
    s_waitcnt lgkmcnt(5)
    v_mfma_f32_32x32x16_bf16 v[40:55], v[24:27], a[52:55], v[40:55]
    buffer_load_dwordx4 a[84:87], v5, s[8:11], s25 offen offset:1024 sc1
    ds_read_b128 v[24:27], v5 offset:49152
    s_waitcnt lgkmcnt(5)
    v_mfma_f32_32x32x16_bf16 v[56:71], a[52:55], v[28:31], v[56:71]
    ds_read_b128 v[28:31], v6 offset:13312
    s_waitcnt lgkmcnt(5)
    v_mfma_f32_32x32x16_bf16 v[40:55], v[32:35], a[56:59], v[40:55]
    buffer_load_dwordx4 a[88:91], v5, s[8:11], s25 offen offset:2048 sc1
    ds_read_b128 v[32:35], v5 offset:50176
    s_waitcnt lgkmcnt(5)
    v_mfma_f32_32x32x16_bf16 v[56:71], a[56:59], v[36:39], v[56:71]
    ds_read_b128 v[36:39], v6 offset:14336
    s_waitcnt lgkmcnt(5)
    v_mfma_f32_32x32x16_bf16 v[40:55], v[16:19], a[60:63], v[40:55]
    buffer_load_dwordx4 a[92:95], v5, s[8:11], s25 offen offset:3072 sc1
    ds_read_b128 v[16:19], v5 offset:51200
    s_waitcnt lgkmcnt(5)
    v_mfma_f32_32x32x16_bf16 v[56:71], a[60:63], v[20:23], v[56:71]
    s_waitcnt vmcnt(4)
    ds_read_b128 v[20:23], v6 offset:15360
    s_waitcnt lgkmcnt(5)
    v_mfma_f32_32x32x16_bf16 v[40:55], v[24:27], a[64:67], v[40:55]
    s_add_u32 s25, s20, 24576
    buffer_load_dwordx4 a[96:99], v5, s[8:11], s25 offen offset:0 sc1
    ds_read_b128 v[24:27], v5 offset:52224
    s_waitcnt lgkmcnt(5)
    v_mfma_f32_32x32x16_bf16 v[56:71], a[64:67], v[28:31], v[56:71]
    ds_read_b128 v[28:31], v6 offset:16384
    s_waitcnt lgkmcnt(5)
    v_mfma_f32_32x32x16_bf16 v[40:55], v[32:35], a[68:71], v[40:55]
    buffer_load_dwordx4 a[100:103], v5, s[8:11], s25 offen offset:1024 sc1
    ds_read_b128 v[32:35], v5 offset:53248
    s_waitcnt lgkmcnt(5)
    v_mfma_f32_32x32x16_bf16 v[56:71], a[68:71], v[36:39], v[56:71]
    ds_read_b128 v[36:39], v6 offset:17408
    s_waitcnt lgkmcnt(5)
    v_mfma_f32_32x32x16_bf16 v[40:55], v[16:19], a[72:75], v[40:55]
    buffer_load_dwordx4 a[104:107], v5, s[8:11], s25 offen offset:2048 sc1
    ds_read_b128 v[16:19], v5 offset:54272
    s_waitcnt lgkmcnt(5)
    v_mfma_f32_32x32x16_bf16 v[56:71], a[72:75], v[20:23], v[56:71]
    ds_read_b128 v[20:23], v6 offset:18432
    s_waitcnt lgkmcnt(5)
    v_mfma_f32_32x32x16_bf16 v[40:55], v[24:27], a[76:79], v[40:55]
    buffer_load_dwordx4 a[108:111], v5, s[8:11], s25 offen offset:3072 sc1
    ds_read_b128 v[24:27], v5 offset:55296
    s_waitcnt lgkmcnt(5)
    v_mfma_f32_32x32x16_bf16 v[56:71], a[76:79], v[28:31], v[56:71]
    s_waitcnt vmcnt(4)
    ds_read_b128 v[28:31], v6 offset:19456
    s_waitcnt lgkmcnt(5)
    v_mfma_f32_32x32x16_bf16 v[40:55], v[32:35], a[80:83], v[40:55]
    ds_read_b128 v[32:35], v5 offset:56320
    s_waitcnt lgkmcnt(5)
    v_mfma_f32_32x32x16_bf16 v[56:71], a[80:83], v[36:39], v[56:71]
    ds_read_b128 v[36:39], v6 offset:20480
    s_waitcnt lgkmcnt(5)
    v_mfma_f32_32x32x16_bf16 v[40:55], v[16:19], a[84:87], v[40:55]
    ds_read_b128 v[16:19], v5 offset:57344
    s_waitcnt lgkmcnt(5)
    v_mfma_f32_32x32x16_bf16 v[56:71], a[84:87], v[20:23], v[56:71]
    ds_read_b128 v[20:23], v6 offset:21504
    s_waitcnt lgkmcnt(5)
    v_mfma_f32_32x32x16_bf16 v[40:55], v[24:27], a[88:91], v[40:55]
    ds_read_b128 v[24:27], v5 offset:58368
    s_waitcnt lgkmcnt(5)
    v_mfma_f32_32x32x16_bf16 v[56:71], a[88:91], v[28:31], v[56:71]
    ds_read_b128 v[28:31], v6 offset:22528
    s_waitcnt lgkmcnt(5)
    v_mfma_f32_32x32x16_bf16 v[40:55], v[32:35], a[92:95], v[40:55]
    ds_read_b128 v[32:35], v5 offset:59392
    s_waitcnt lgkmcnt(5)
    v_mfma_f32_32x32x16_bf16 v[56:71], a[92:95], v[36:39], v[56:71]
    s_waitcnt vmcnt(0)
    ds_read_b128 v[36:39], v6 offset:23552
    s_waitcnt lgkmcnt(5)
    v_mfma_f32_32x32x16_bf16 v[40:55], v[16:19], a[96:99], v[40:55]
    ds_read_b128 v[16:19], v5 offset:60416
    s_waitcnt lgkmcnt(5)
    v_mfma_f32_32x32x16_bf16 v[56:71], a[96:99], v[20:23], v[56:71]
    ds_read_b128 v[20:23], v6 offset:24576
    s_waitcnt lgkmcnt(5)
    v_mfma_f32_32x32x16_bf16 v[40:55], v[24:27], a[100:103], v[40:55]
    s_waitcnt lgkmcnt(4)
    v_mfma_f32_32x32x16_bf16 v[56:71], a[100:103], v[28:31], v[56:71]
    s_waitcnt lgkmcnt(3)
    v_mfma_f32_32x32x16_bf16 v[40:55], v[32:35], a[104:107], v[40:55]
    s_waitcnt lgkmcnt(2)
    v_mfma_f32_32x32x16_bf16 v[56:71], a[104:107], v[36:39], v[56:71]
    s_waitcnt lgkmcnt(1)
    v_mfma_f32_32x32x16_bf16 v[40:55], v[16:19], a[108:111], v[40:55]
    s_waitcnt lgkmcnt(0)
    v_mfma_f32_32x32x16_bf16 v[56:71], a[108:111], v[20:23], v[56:71]
    s_branch L_qkvA_epiTN
L_qkvA_tr:
    s_cmp_ge_u32 s12, 4
    s_cbranch_scc1 L_qkvA_sig
    s_mul_i32 s20, s15, 28672
    s_add_u32 s20, s20, s60
    s_cmp_eq_u32 s17, 8
    s_cbranch_scc1 L_qkvA_kv_tr
    s_lshl_b32 s32, s15, 4
    s_lshl_b32 s33, s17, 1
    s_add_u32 s32, s32, s33
    s_lshl_b32 s32, s32, 11
    s_add_u32 s32, s32, s60
    s_add_u32 s32, s32, 0x200000
    s_add_u32 s33, s32, 2048
    s_add_u32 s25, s20, 0
    buffer_load_dwordx4 a[0:3], v5, s[8:11], s25 offen offset:0 sc1
    buffer_load_dwordx4 a[4:7], v5, s[8:11], s25 offen offset:1024 sc1
    buffer_load_dwordx4 a[8:11], v5, s[8:11], s25 offen offset:2048 sc1
    buffer_load_dwordx4 a[12:15], v5, s[8:11], s25 offen offset:3072 sc1
    v_lshlrev_b32 v10, 4, v3
    v_lshl_add_u32 v10, v4, 11, v10
    s_lshl_b32 s27, s15, 12
    s_add_u32 s27, s27, s60
    s_add_u32 s27, s27, 0x1c0000
    buffer_load_dwordx4 v[72:75], v10, s[8:11], s27 offen offset:0 sc1
    buffer_load_dwordx4 v[76:79], v10, s[8:11], s27 offen offset:512 sc1
    buffer_load_dwordx4 v[80:83], v10, s[8:11], s27 offen offset:1024 sc1
    buffer_load_dwordx4 v[84:87], v10, s[8:11], s27 offen offset:1536 sc1
    v_lshlrev_b32 v11, 4, v4
    v_add_u32 v11, 61440, v11
    ds_read_b128 v[88:91], v11 offset:0
    ds_read_b128 v[92:95], v11 offset:32
    ds_read_b128 v[96:99], v11 offset:64
    ds_read_b128 v[100:103], v11 offset:96
    v_lshlrev_b32 v11, 4, v4
    v_add_u32 v11, 91136, v11
    ds_read_b128 v[104:107], v11 offset:0
    ds_read_b128 v[108:111], v11 offset:32
    ds_read_b128 v[112:115], v11 offset:64
    ds_read_b128 v[116:119], v11 offset:96
    s_add_u32 s25, s20, 4096
    buffer_load_dwordx4 a[16:19], v5, s[8:11], s25 offen offset:0 sc1
    buffer_load_dwordx4 a[20:23], v5, s[8:11], s25 offen offset:1024 sc1
    buffer_load_dwordx4 a[24:27], v5, s[8:11], s25 offen offset:2048 sc1
    buffer_load_dwordx4 a[28:31], v5, s[8:11], s25 offen offset:3072 sc1
    ds_read_b64_tr_b16 v[16:17], v15 offset:0
    ds_read_b64_tr_b16 v[18:19], v15 offset:512
    ds_read_b64_tr_b16 v[20:21], v15 offset:29696
    ds_read_b64_tr_b16 v[22:23], v15 offset:30208
    ds_read_b64_tr_b16 v[24:25], v15 offset:1024
    ds_read_b64_tr_b16 v[26:27], v15 offset:1536
    ds_read_b64_tr_b16 v[28:29], v15 offset:30720
    ds_read_b64_tr_b16 v[30:31], v15 offset:31232
    ds_read_b64_tr_b16 v[32:33], v15 offset:2048
    ds_read_b64_tr_b16 v[34:35], v15 offset:2560
    s_waitcnt vmcnt(8)
    ds_read_b64_tr_b16 v[36:37], v15 offset:31744
    ds_read_b64_tr_b16 v[38:39], v15 offset:32256
    s_waitcnt lgkmcnt(10)
    v_mfma_f32_32x32x16_bf16 v[40:55], v[16:19], a[0:3], 0
    s_add_u32 s25, s20, 8192
    buffer_load_dwordx4 a[32:35], v5, s[8:11], s25 offen offset:0 sc1
    ds_read_b64_tr_b16 v[16:17], v15 offset:3072
    ds_read_b64_tr_b16 v[18:19], v15 offset:3584
    s_waitcnt lgkmcnt(10)
    v_mfma_f32_32x32x16_bf16 v[56:71], v[20:23], a[0:3], 0
    ds_read_b64_tr_b16 v[20:21], v15 offset:32768
    ds_read_b64_tr_b16 v[22:23], v15 offset:33280
    s_waitcnt lgkmcnt(10)
    v_mfma_f32_32x32x16_bf16 v[40:55], v[24:27], a[4:7], v[40:55]
    buffer_load_dwordx4 a[36:39], v5, s[8:11], s25 offen offset:1024 sc1
    ds_read_b64_tr_b16 v[24:25], v15 offset:4096
    ds_read_b64_tr_b16 v[26:27], v15 offset:4608
    s_waitcnt lgkmcnt(10)
    v_mfma_f32_32x32x16_bf16 v[56:71], v[28:31], a[4:7], v[56:71]
    ds_read_b64_tr_b16 v[28:29], v15 offset:33792
    ds_read_b64_tr_b16 v[30:31], v15 offset:34304
    s_waitcnt lgkmcnt(10)
    v_mfma_f32_32x32x16_bf16 v[40:55], v[32:35], a[8:11], v[40:55]
    buffer_load_dwordx4 a[40:43], v5, s[8:11], s25 offen offset:2048 sc1
    ds_read_b64_tr_b16 v[32:33], v15 offset:5120
    ds_read_b64_tr_b16 v[34:35], v15 offset:5632
    s_waitcnt lgkmcnt(10)
    v_mfma_f32_32x32x16_bf16 v[56:71], v[36:39], a[8:11], v[56:71]
    ds_read_b64_tr_b16 v[36:37], v15 offset:34816
    ds_read_b64_tr_b16 v[38:39], v15 offset:35328
    s_waitcnt lgkmcnt(10)
    v_mfma_f32_32x32x16_bf16 v[40:55], v[16:19], a[12:15], v[40:55]
    buffer_load_dwordx4 a[44:47], v5, s[8:11], s25 offen offset:3072 sc1
    ds_read_b64_tr_b16 v[16:17], v15 offset:6144
    ds_read_b64_tr_b16 v[18:19], v15 offset:6656
    s_waitcnt lgkmcnt(10)
    v_mfma_f32_32x32x16_bf16 v[56:71], v[20:23], a[12:15], v[56:71]
    s_waitcnt vmcnt(4)
    ds_read_b64_tr_b16 v[20:21], v15 offset:35840
    ds_read_b64_tr_b16 v[22:23], v15 offset:36352
    s_waitcnt lgkmcnt(10)
    v_mfma_f32_32x32x16_bf16 v[40:55], v[24:27], a[16:19], v[40:55]
    s_add_u32 s25, s20, 12288
    buffer_load_dwordx4 a[48:51], v5, s[8:11], s25 offen offset:0 sc1
    v_cmp_eq_u32 vcc, 0, v4
    s_nop 1
    v_cndmask_b32 v12, 0, -1, vcc
    v_and_b32 v84, v84, v12
    v_and_b32 v85, v85, v12
    v_and_b32 v86, v86, v12
    v_and_b32 v87, v87, v12
    v_add_f32 v72, v72, v74
    v_add_f32 v73, v73, v75
    v_add_f32 v72, v72, v76
    v_add_f32 v73, v73, v77
    v_add_f32 v72, v72, v78
    v_add_f32 v73, v73, v79
    v_add_f32 v72, v72, v80
    v_add_f32 v73, v73, v81
    v_add_f32 v72, v72, v82
    v_add_f32 v73, v73, v83
    v_add_f32 v72, v72, v84
    v_add_f32 v73, v73, v85
    v_add_f32 v72, v72, v86
    v_add_f32 v73, v73, v87
    v_mov_b32 v74, v72
    v_mov_b32 v75, v73
    s_nop 0
    v_permlane32_swap_b32 v72, v74
    v_permlane32_swap_b32 v73, v75
    v_add_f32 v72, v72, v74
    v_add_f32 v73, v73, v75
    v_mul_f32 v8, 0xbb124925, v72
    v_mul_f32 v10, 0x3b124925, v73
    v_fma_f32 v10, -v8, v8, v10
    v_max_f32 v10, 0, v10
    v_add_f32 v10, 0x3727c5ac, v10
    v_rsq_f32 v9, v10
    s_nop 0
    v_mul_f32 v14, 0x3e8b97f6, v9
    ds_read_b64_tr_b16 v[24:25], v15 offset:7168
    ds_read_b64_tr_b16 v[26:27], v15 offset:7680
    s_waitcnt lgkmcnt(10)
    v_mfma_f32_32x32x16_bf16 v[56:71], v[28:31], a[16:19], v[56:71]
    ds_read_b64_tr_b16 v[28:29], v15 offset:36864
    ds_read_b64_tr_b16 v[30:31], v15 offset:37376
    s_waitcnt lgkmcnt(10)
    v_mfma_f32_32x32x16_bf16 v[40:55], v[32:35], a[20:23], v[40:55]
    buffer_load_dwordx4 a[52:55], v5, s[8:11], s25 offen offset:1024 sc1
    ds_read_b64_tr_b16 v[32:33], v15 offset:8192
    ds_read_b64_tr_b16 v[34:35], v15 offset:8704
    s_waitcnt lgkmcnt(10)
    v_mfma_f32_32x32x16_bf16 v[56:71], v[36:39], a[20:23], v[56:71]
    ds_read_b64_tr_b16 v[36:37], v15 offset:37888
    ds_read_b64_tr_b16 v[38:39], v15 offset:38400
    s_waitcnt lgkmcnt(10)
    v_mfma_f32_32x32x16_bf16 v[40:55], v[16:19], a[24:27], v[40:55]
    buffer_load_dwordx4 a[56:59], v5, s[8:11], s25 offen offset:2048 sc1
    ds_read_b64_tr_b16 v[16:17], v15 offset:9216
    ds_read_b64_tr_b16 v[18:19], v15 offset:9728
    s_waitcnt lgkmcnt(10)
    v_mfma_f32_32x32x16_bf16 v[56:71], v[20:23], a[24:27], v[56:71]
    ds_read_b64_tr_b16 v[20:21], v15 offset:38912
    ds_read_b64_tr_b16 v[22:23], v15 offset:39424
    s_waitcnt lgkmcnt(10)
    v_mfma_f32_32x32x16_bf16 v[40:55], v[24:27], a[28:31], v[40:55]
    buffer_load_dwordx4 a[60:63], v5, s[8:11], s25 offen offset:3072 sc1
    ds_read_b64_tr_b16 v[24:25], v15 offset:10240
    ds_read_b64_tr_b16 v[26:27], v15 offset:10752
    s_waitcnt lgkmcnt(10)
    v_mfma_f32_32x32x16_bf16 v[56:71], v[28:31], a[28:31], v[56:71]
    s_waitcnt vmcnt(4)
    ds_read_b64_tr_b16 v[28:29], v15 offset:39936
    ds_read_b64_tr_b16 v[30:31], v15 offset:40448
    s_waitcnt lgkmcnt(10)
    v_mfma_f32_32x32x16_bf16 v[40:55], v[32:35], a[32:35], v[40:55]
    s_add_u32 s25, s20, 16384
    buffer_load_dwordx4 a[64:67], v5, s[8:11], s25 offen offset:0 sc1
    ds_read_b64_tr_b16 v[32:33], v15 offset:11264
    ds_read_b64_tr_b16 v[34:35], v15 offset:11776
    s_waitcnt lgkmcnt(10)
    v_mfma_f32_32x32x16_bf16 v[56:71], v[36:39], a[32:35], v[56:71]
    ds_read_b64_tr_b16 v[36:37], v15 offset:40960
    ds_read_b64_tr_b16 v[38:39], v15 offset:41472
    s_waitcnt lgkmcnt(10)
    v_mfma_f32_32x32x16_bf16 v[40:55], v[16:19], a[36:39], v[40:55]
    buffer_load_dwordx4 a[68:71], v5, s[8:11], s25 offen offset:1024 sc1
    ds_read_b64_tr_b16 v[16:17], v15 offset:12288
    ds_read_b64_tr_b16 v[18:19], v15 offset:12800
    s_waitcnt lgkmcnt(10)
    v_mfma_f32_32x32x16_bf16 v[56:71], v[20:23], a[36:39], v[56:71]
    ds_read_b64_tr_b16 v[20:21], v15 offset:41984
    ds_read_b64_tr_b16 v[22:23], v15 offset:42496
    s_waitcnt lgkmcnt(10)
    v_mfma_f32_32x32x16_bf16 v[40:55], v[24:27], a[40:43], v[40:55]
    buffer_load_dwordx4 a[72:75], v5, s[8:11], s25 offen offset:2048 sc1
    ds_read_b64_tr_b16 v[24:25], v15 offset:13312
    ds_read_b64_tr_b16 v[26:27], v15 offset:13824
    s_waitcnt lgkmcnt(10)
    v_mfma_f32_32x32x16_bf16 v[56:71], v[28:31], a[40:43], v[56:71]
    ds_read_b64_tr_b16 v[28:29], v15 offset:43008
    ds_read_b64_tr_b16 v[30:31], v15 offset:43520
    s_waitcnt lgkmcnt(10)
    v_mfma_f32_32x32x16_bf16 v[40:55], v[32:35], a[44:47], v[40:55]
    buffer_load_dwordx4 a[76:79], v5, s[8:11], s25 offen offset:3072 sc1
    ds_read_b64_tr_b16 v[32:33], v15 offset:14336
    ds_read_b64_tr_b16 v[34:35], v15 offset:14848
    s_waitcnt lgkmcnt(10)
    v_mfma_f32_32x32x16_bf16 v[56:71], v[36:39], a[44:47], v[56:71]
    s_waitcnt vmcnt(4)
    ds_read_b64_tr_b16 v[36:37], v15 offset:44032
    ds_read_b64_tr_b16 v[38:39], v15 offset:44544
    s_waitcnt lgkmcnt(10)
    v_mfma_f32_32x32x16_bf16 v[40:55], v[16:19], a[48:51], v[40:55]
    s_add_u32 s25, s20, 20480
    buffer_load_dwordx4 a[80:83], v5, s[8:11], s25 offen offset:0 sc1
    ds_read_b64_tr_b16 v[16:17], v15 offset:15360
    ds_read_b64_tr_b16 v[18:19], v15 offset:15872
    s_waitcnt lgkmcnt(10)
    v_mfma_f32_32x32x16_bf16 v[56:71], v[20:23], a[48:51], v[56:71]
    ds_read_b64_tr_b16 v[20:21], v15 offset:45056
    ds_read_b64_tr_b16 v[22:23], v15 offset:45568
    s_waitcnt lgkmcnt(10)
    v_mfma_f32_32x32x16_bf16 v[40:55], v[24:27], a[52:55], v[40:55]
    buffer_load_dwordx4 a[84:87], v5, s[8:11], s25 offen offset:1024 sc1
    ds_read_b64_tr_b16 v[24:25], v15 offset:16384
    ds_read_b64_tr_b16 v[26:27], v15 offset:16896
    s_waitcnt lgkmcnt(10)
    v_mfma_f32_32x32x16_bf16 v[56:71], v[28:31], a[52:55], v[56:71]
    ds_read_b64_tr_b16 v[28:29], v15 offset:46080
    ds_read_b64_tr_b16 v[30:31], v15 offset:46592
    s_waitcnt lgkmcnt(10)
    v_mfma_f32_32x32x16_bf16 v[40:55], v[32:35], a[56:59], v[40:55]
    buffer_load_dwordx4 a[88:91], v5, s[8:11], s25 offen offset:2048 sc1
    ds_read_b64_tr_b16 v[32:33], v15 offset:17408
    ds_read_b64_tr_b16 v[34:35], v15 offset:17920
    s_waitcnt lgkmcnt(10)
    v_mfma_f32_32x32x16_bf16 v[56:71], v[36:39], a[56:59], v[56:71]
    ds_read_b64_tr_b16 v[36:37], v15 offset:47104
    ds_read_b64_tr_b16 v[38:39], v15 offset:47616
    s_waitcnt lgkmcnt(10)
    v_mfma_f32_32x32x16_bf16 v[40:55], v[16:19], a[60:63], v[40:55]
    buffer_load_dwordx4 a[92:95], v5, s[8:11], s25 offen offset:3072 sc1
    ds_read_b64_tr_b16 v[16:17], v15 offset:18432
    ds_read_b64_tr_b16 v[18:19], v15 offset:18944
    s_waitcnt lgkmcnt(10)
    v_mfma_f32_32x32x16_bf16 v[56:71], v[20:23], a[60:63], v[56:71]
    s_waitcnt vmcnt(4)
    ds_read_b64_tr_b16 v[20:21], v15 offset:48128
    ds_read_b64_tr_b16 v[22:23], v15 offset:48640
    s_waitcnt lgkmcnt(10)
    v_mfma_f32_32x32x16_bf16 v[40:55], v[24:27], a[64:67], v[40:55]
    s_add_u32 s25, s20, 24576
    buffer_load_dwordx4 a[96:99], v5, s[8:11], s25 offen offset:0 sc1
    ds_read_b64_tr_b16 v[24:25], v15 offset:19456
    ds_read_b64_tr_b16 v[26:27], v15 offset:19968
    s_waitcnt lgkmcnt(10)
    v_mfma_f32_32x32x16_bf16 v[56:71], v[28:31], a[64:67], v[56:71]
    ds_read_b64_tr_b16 v[28:29], v15 offset:49152
    ds_read_b64_tr_b16 v[30:31], v15 offset:49664
    s_waitcnt lgkmcnt(10)
    v_mfma_f32_32x32x16_bf16 v[40:55], v[32:35], a[68:71], v[40:55]
    buffer_load_dwordx4 a[100:103], v5, s[8:11], s25 offen offset:1024 sc1
    ds_read_b64_tr_b16 v[32:33], v15 offset:20480
    ds_read_b64_tr_b16 v[34:35], v15 offset:20992
    s_waitcnt lgkmcnt(10)
    v_mfma_f32_32x32x16_bf16 v[56:71], v[36:39], a[68:71], v[56:71]
    ds_read_b64_tr_b16 v[36:37], v15 offset:50176
    ds_read_b64_tr_b16 v[38:39], v15 offset:50688
    s_waitcnt lgkmcnt(10)
    v_mfma_f32_32x32x16_bf16 v[40:55], v[16:19], a[72:75], v[40:55]
    buffer_load_dwordx4 a[104:107], v5, s[8:11], s25 offen offset:2048 sc1
    ds_read_b64_tr_b16 v[16:17], v15 offset:21504
    ds_read_b64_tr_b16 v[18:19], v15 offset:22016
    s_waitcnt lgkmcnt(10)
    v_mfma_f32_32x32x16_bf16 v[56:71], v[20:23], a[72:75], v[56:71]
    ds_read_b64_tr_b16 v[20:21], v15 offset:51200
    ds_read_b64_tr_b16 v[22:23], v15 offset:51712
    s_waitcnt lgkmcnt(10)
    v_mfma_f32_32x32x16_bf16 v[40:55], v[24:27], a[76:79], v[40:55]
    buffer_load_dwordx4 a[108:111], v5, s[8:11], s25 offen offset:3072 sc1
    ds_read_b64_tr_b16 v[24:25], v15 offset:22528
    ds_read_b64_tr_b16 v[26:27], v15 offset:23040
    s_waitcnt lgkmcnt(10)
    v_mfma_f32_32x32x16_bf16 v[56:71], v[28:31], a[76:79], v[56:71]
    s_waitcnt vmcnt(4)
    ds_read_b64_tr_b16 v[28:29], v15 offset:52224
    ds_read_b64_tr_b16 v[30:31], v15 offset:52736
    s_waitcnt lgkmcnt(10)
    v_mfma_f32_32x32x16_bf16 v[40:55], v[32:35], a[80:83], v[40:55]
    ds_read_b64_tr_b16 v[32:33], v15 offset:23552
    ds_read_b64_tr_b16 v[34:35], v15 offset:24064
    s_waitcnt lgkmcnt(10)
    v_mfma_f32_32x32x16_bf16 v[56:71], v[36:39], a[80:83], v[56:71]
    ds_read_b64_tr_b16 v[36:37], v15 offset:53248
    ds_read_b64_tr_b16 v[38:39], v15 offset:53760
    s_waitcnt lgkmcnt(10)
    v_mfma_f32_32x32x16_bf16 v[40:55], v[16:19], a[84:87], v[40:55]
    ds_read_b64_tr_b16 v[16:17], v15 offset:24576
    ds_read_b64_tr_b16 v[18:19], v15 offset:25088
    s_waitcnt lgkmcnt(10)
    v_mfma_f32_32x32x16_bf16 v[56:71], v[20:23], a[84:87], v[56:71]
    ds_read_b64_tr_b16 v[20:21], v15 offset:54272
    ds_read_b64_tr_b16 v[22:23], v15 offset:54784
    s_waitcnt lgkmcnt(10)
    v_mfma_f32_32x32x16_bf16 v[40:55], v[24:27], a[88:91], v[40:55]
    ds_read_b64_tr_b16 v[24:25], v15 offset:25600
    ds_read_b64_tr_b16 v[26:27], v15 offset:26112
    s_waitcnt lgkmcnt(10)
    v_mfma_f32_32x32x16_bf16 v[56:71], v[28:31], a[88:91], v[56:71]
    ds_read_b64_tr_b16 v[28:29], v15 offset:55296
    ds_read_b64_tr_b16 v[30:31], v15 offset:55808
    s_waitcnt lgkmcnt(10)
    v_mfma_f32_32x32x16_bf16 v[40:55], v[32:35], a[92:95], v[40:55]
    ds_read_b64_tr_b16 v[32:33], v15 offset:26624
    ds_read_b64_tr_b16 v[34:35], v15 offset:27136
    s_waitcnt lgkmcnt(10)
    v_mfma_f32_32x32x16_bf16 v[56:71], v[36:39], a[92:95], v[56:71]
    s_waitcnt vmcnt(0)
    ds_read_b64_tr_b16 v[36:37], v15 offset:56320
    ds_read_b64_tr_b16 v[38:39], v15 offset:56832
    s_waitcnt lgkmcnt(10)
    v_mfma_f32_32x32x16_bf16 v[40:55], v[16:19], a[96:99], v[40:55]
    ds_read_b64_tr_b16 v[16:17], v15 offset:27648
    ds_read_b64_tr_b16 v[18:19], v15 offset:28160
    s_waitcnt lgkmcnt(10)
    v_mfma_f32_32x32x16_bf16 v[56:71], v[20:23], a[96:99], v[56:71]
    ds_read_b64_tr_b16 v[20:21], v15 offset:57344
    ds_read_b64_tr_b16 v[22:23], v15 offset:57856
    s_waitcnt lgkmcnt(10)
    v_mfma_f32_32x32x16_bf16 v[40:55], v[24:27], a[100:103], v[40:55]
    s_waitcnt lgkmcnt(8)
    v_mfma_f32_32x32x16_bf16 v[56:71], v[28:31], a[100:103], v[56:71]
    s_waitcnt lgkmcnt(6)
    v_mfma_f32_32x32x16_bf16 v[40:55], v[32:35], a[104:107], v[40:55]
    s_waitcnt lgkmcnt(4)
    v_mfma_f32_32x32x16_bf16 v[56:71], v[36:39], a[104:107], v[56:71]
    s_waitcnt lgkmcnt(2)
    v_mfma_f32_32x32x16_bf16 v[40:55], v[16:19], a[108:111], v[40:55]
    s_waitcnt lgkmcnt(0)
    v_mfma_f32_32x32x16_bf16 v[56:71], v[20:23], a[108:111], v[56:71]
    s_branch L_qkvA_epiTT
L_qkvA_kv_tr:
    s_lshl_b32 s32, s15, 12
    s_add_u32 s32, s32, s60
    s_add_u32 s32, s32, 0xa00000
    s_lshl_b32 s33, s62, 19
    s_add_u32 s32, s32, s33
    s_add_u32 s33, s32, 2048
    s_add_u32 s25, s20, 0
    buffer_load_dwordx4 a[0:3], v5, s[8:11], s25 offen offset:0 sc1
    buffer_load_dwordx4 a[4:7], v5, s[8:11], s25 offen offset:1024 sc1
    buffer_load_dwordx4 a[8:11], v5, s[8:11], s25 offen offset:2048 sc1
    buffer_load_dwordx4 a[12:15], v5, s[8:11], s25 offen offset:3072 sc1
    v_lshlrev_b32 v10, 4, v3
    v_lshl_add_u32 v10, v4, 11, v10
    s_lshl_b32 s27, s15, 12
    s_add_u32 s27, s27, s60
    s_add_u32 s27, s27, 0x1c0000
    buffer_load_dwordx4 v[72:75], v10, s[8:11], s27 offen offset:0 sc1
    buffer_load_dwordx4 v[76:79], v10, s[8:11], s27 offen offset:512 sc1
    buffer_load_dwordx4 v[80:83], v10, s[8:11], s27 offen offset:1024 sc1
    buffer_load_dwordx4 v[84:87], v10, s[8:11], s27 offen offset:1536 sc1
    v_lshlrev_b32 v11, 4, v4
    v_add_u32 v11, 61440, v11
    ds_read_b128 v[88:91], v11 offset:0
    ds_read_b128 v[92:95], v11 offset:32
    ds_read_b128 v[96:99], v11 offset:64
    ds_read_b128 v[100:103], v11 offset:96
    v_lshlrev_b32 v11, 2, v3
    v_add_u32 v11, 91136, v11
    ds_read_b32 v104, v11
    s_add_u32 s25, s20, 4096
    buffer_load_dwordx4 a[16:19], v5, s[8:11], s25 offen offset:0 sc1
    buffer_load_dwordx4 a[20:23], v5, s[8:11], s25 offen offset:1024 sc1
    buffer_load_dwordx4 a[24:27], v5, s[8:11], s25 offen offset:2048 sc1
    buffer_load_dwordx4 a[28:31], v5, s[8:11], s25 offen offset:3072 sc1
    ds_read_b64_tr_b16 v[16:17], v15 offset:0
    ds_read_b64_tr_b16 v[18:19], v15 offset:512
    ds_read_b64_tr_b16 v[20:21], v15 offset:29696
    ds_read_b64_tr_b16 v[22:23], v15 offset:30208
    ds_read_b64_tr_b16 v[24:25], v15 offset:1024
    ds_read_b64_tr_b16 v[26:27], v15 offset:1536
    ds_read_b64_tr_b16 v[28:29], v15 offset:30720
    ds_read_b64_tr_b16 v[30:31], v15 offset:31232
    ds_read_b64_tr_b16 v[32:33], v15 offset:2048
    ds_read_b64_tr_b16 v[34:35], v15 offset:2560
    s_waitcnt vmcnt(8)
    ds_read_b64_tr_b16 v[36:37], v15 offset:31744
    ds_read_b64_tr_b16 v[38:39], v15 offset:32256
    s_waitcnt lgkmcnt(10)
    v_mfma_f32_32x32x16_bf16 v[40:55], v[16:19], a[0:3], 0
    s_add_u32 s25, s20, 8192
    buffer_load_dwordx4 a[32:35], v5, s[8:11], s25 offen offset:0 sc1
    ds_read_b64_tr_b16 v[16:17], v15 offset:3072
    ds_read_b64_tr_b16 v[18:19], v15 offset:3584
    s_waitcnt lgkmcnt(10)
    v_mfma_f32_32x32x16_bf16 v[56:71], a[0:3], v[20:23], 0
    ds_read_b64_tr_b16 v[20:21], v15 offset:32768
    ds_read_b64_tr_b16 v[22:23], v15 offset:33280
    s_waitcnt lgkmcnt(10)
    v_mfma_f32_32x32x16_bf16 v[40:55], v[24:27], a[4:7], v[40:55]
    buffer_load_dwordx4 a[36:39], v5, s[8:11], s25 offen offset:1024 sc1
    ds_read_b64_tr_b16 v[24:25], v15 offset:4096
    ds_read_b64_tr_b16 v[26:27], v15 offset:4608
    s_waitcnt lgkmcnt(10)
    v_mfma_f32_32x32x16_bf16 v[56:71], a[4:7], v[28:31], v[56:71]
    ds_read_b64_tr_b16 v[28:29], v15 offset:33792
    ds_read_b64_tr_b16 v[30:31], v15 offset:34304
    s_waitcnt lgkmcnt(10)
    v_mfma_f32_32x32x16_bf16 v[40:55], v[32:35], a[8:11], v[40:55]
    buffer_load_dwordx4 a[40:43], v5, s[8:11], s25 offen offset:2048 sc1
    ds_read_b64_tr_b16 v[32:33], v15 offset:5120
    ds_read_b64_tr_b16 v[34:35], v15 offset:5632
    s_waitcnt lgkmcnt(10)
    v_mfma_f32_32x32x16_bf16 v[56:71], a[8:11], v[36:39], v[56:71]
    ds_read_b64_tr_b16 v[36:37], v15 offset:34816
    ds_read_b64_tr_b16 v[38:39], v15 offset:35328
    s_waitcnt lgkmcnt(10)
    v_mfma_f32_32x32x16_bf16 v[40:55], v[16:19], a[12:15], v[40:55]
    buffer_load_dwordx4 a[44:47], v5, s[8:11], s25 offen offset:3072 sc1
    ds_read_b64_tr_b16 v[16:17], v15 offset:6144
    ds_read_b64_tr_b16 v[18:19], v15 offset:6656
    s_waitcnt lgkmcnt(10)
    v_mfma_f32_32x32x16_bf16 v[56:71], a[12:15], v[20:23], v[56:71]
    s_waitcnt vmcnt(4)
    ds_read_b64_tr_b16 v[20:21], v15 offset:35840
    ds_read_b64_tr_b16 v[22:23], v15 offset:36352
    s_waitcnt lgkmcnt(10)
    v_mfma_f32_32x32x16_bf16 v[40:55], v[24:27], a[16:19], v[40:55]
    s_add_u32 s25, s20, 12288
    buffer_load_dwordx4 a[48:51], v5, s[8:11], s25 offen offset:0 sc1
    v_cmp_eq_u32 vcc, 0, v4
    s_nop 1
    v_cndmask_b32 v12, 0, -1, vcc
    v_and_b32 v84, v84, v12
    v_and_b32 v85, v85, v12
    v_and_b32 v86, v86, v12
    v_and_b32 v87, v87, v12
    v_add_f32 v72, v72, v74
    v_add_f32 v73, v73, v75
    v_add_f32 v72, v72, v76
    v_add_f32 v73, v73, v77
    v_add_f32 v72, v72, v78
    v_add_f32 v73, v73, v79
    v_add_f32 v72, v72, v80
    v_add_f32 v73, v73, v81
    v_add_f32 v72, v72, v82
    v_add_f32 v73, v73, v83
    v_add_f32 v72, v72, v84
    v_add_f32 v73, v73, v85
    v_add_f32 v72, v72, v86
    v_add_f32 v73, v73, v87
    v_mov_b32 v74, v72
    v_mov_b32 v75, v73
    s_nop 0
    v_permlane32_swap_b32 v72, v74
    v_permlane32_swap_b32 v73, v75
    v_add_f32 v72, v72, v74
    v_add_f32 v73, v73, v75
    v_mul_f32 v8, 0xbb124925, v72
    v_mul_f32 v10, 0x3b124925, v73
    v_fma_f32 v10, -v8, v8, v10
    v_max_f32 v10, 0, v10
    v_add_f32 v10, 0x3727c5ac, v10
    v_rsq_f32 v9, v10
    s_nop 0
    v_mul_f32 v14, 0x3e8b97f6, v9
    ds_read_b64_tr_b16 v[24:25], v15 offset:7168
    ds_read_b64_tr_b16 v[26:27], v15 offset:7680
    s_waitcnt lgkmcnt(10)
    v_mfma_f32_32x32x16_bf16 v[56:71], a[16:19], v[28:31], v[56:71]
    ds_read_b64_tr_b16 v[28:29], v15 offset:36864
    ds_read_b64_tr_b16 v[30:31], v15 offset:37376
    s_waitcnt lgkmcnt(10)
    v_mfma_f32_32x32x16_bf16 v[40:55], v[32:35], a[20:23], v[40:55]
    buffer_load_dwordx4 a[52:55], v5, s[8:11], s25 offen offset:1024 sc1
    ds_read_b64_tr_b16 v[32:33], v15 offset:8192
    ds_read_b64_tr_b16 v[34:35], v15 offset:8704
    s_waitcnt lgkmcnt(10)
    v_mfma_f32_32x32x16_bf16 v[56:71], a[20:23], v[36:39], v[56:71]
    ds_read_b64_tr_b16 v[36:37], v15 offset:37888
    ds_read_b64_tr_b16 v[38:39], v15 offset:38400
    s_waitcnt lgkmcnt(10)
    v_mfma_f32_32x32x16_bf16 v[40:55], v[16:19], a[24:27], v[40:55]
    buffer_load_dwordx4 a[56:59], v5, s[8:11], s25 offen offset:2048 sc1
    ds_read_b64_tr_b16 v[16:17], v15 offset:9216
    ds_read_b64_tr_b16 v[18:19], v15 offset:9728
    s_waitcnt lgkmcnt(10)
    v_mfma_f32_32x32x16_bf16 v[56:71], a[24:27], v[20:23], v[56:71]
    ds_read_b64_tr_b16 v[20:21], v15 offset:38912
    ds_read_b64_tr_b16 v[22:23], v15 offset:39424
    s_waitcnt lgkmcnt(10)
    v_mfma_f32_32x32x16_bf16 v[40:55], v[24:27], a[28:31], v[40:55]
    buffer_load_dwordx4 a[60:63], v5, s[8:11], s25 offen offset:3072 sc1
    ds_read_b64_tr_b16 v[24:25], v15 offset:10240
    ds_read_b64_tr_b16 v[26:27], v15 offset:10752
    s_waitcnt lgkmcnt(10)
    v_mfma_f32_32x32x16_bf16 v[56:71], a[28:31], v[28:31], v[56:71]
    s_waitcnt vmcnt(4)
    ds_read_b64_tr_b16 v[28:29], v15 offset:39936
    ds_read_b64_tr_b16 v[30:31], v15 offset:40448
    s_waitcnt lgkmcnt(10)
    v_mfma_f32_32x32x16_bf16 v[40:55], v[32:35], a[32:35], v[40:55]
    s_add_u32 s25, s20, 16384
    buffer_load_dwordx4 a[64:67], v5, s[8:11], s25 offen offset:0 sc1
    ds_read_b64_tr_b16 v[32:33], v15 offset:11264
    ds_read_b64_tr_b16 v[34:35], v15 offset:11776
    s_waitcnt lgkmcnt(10)
    v_mfma_f32_32x32x16_bf16 v[56:71], a[32:35], v[36:39], v[56:71]
    ds_read_b64_tr_b16 v[36:37], v15 offset:40960
    ds_read_b64_tr_b16 v[38:39], v15 offset:41472
    s_waitcnt lgkmcnt(10)
    v_mfma_f32_32x32x16_bf16 v[40:55], v[16:19], a[36:39], v[40:55]
    buffer_load_dwordx4 a[68:71], v5, s[8:11], s25 offen offset:1024 sc1
    ds_read_b64_tr_b16 v[16:17], v15 offset:12288
    ds_read_b64_tr_b16 v[18:19], v15 offset:12800
    s_waitcnt lgkmcnt(10)
    v_mfma_f32_32x32x16_bf16 v[56:71], a[36:39], v[20:23], v[56:71]
    ds_read_b64_tr_b16 v[20:21], v15 offset:41984
    ds_read_b64_tr_b16 v[22:23], v15 offset:42496
    s_waitcnt lgkmcnt(10)
    v_mfma_f32_32x32x16_bf16 v[40:55], v[24:27], a[40:43], v[40:55]
    buffer_load_dwordx4 a[72:75], v5, s[8:11], s25 offen offset:2048 sc1
    ds_read_b64_tr_b16 v[24:25], v15 offset:13312
    ds_read_b64_tr_b16 v[26:27], v15 offset:13824
    s_waitcnt lgkmcnt(10)
    v_mfma_f32_32x32x16_bf16 v[56:71], a[40:43], v[28:31], v[56:71]
    ds_read_b64_tr_b16 v[28:29], v15 offset:43008
    ds_read_b64_tr_b16 v[30:31], v15 offset:43520
    s_waitcnt lgkmcnt(10)
    v_mfma_f32_32x32x16_bf16 v[40:55], v[32:35], a[44:47], v[40:55]
    buffer_load_dwordx4 a[76:79], v5, s[8:11], s25 offen offset:3072 sc1
    ds_read_b64_tr_b16 v[32:33], v15 offset:14336
    ds_read_b64_tr_b16 v[34:35], v15 offset:14848
    s_waitcnt lgkmcnt(10)
    v_mfma_f32_32x32x16_bf16 v[56:71], a[44:47], v[36:39], v[56:71]
    s_waitcnt vmcnt(4)
    ds_read_b64_tr_b16 v[36:37], v15 offset:44032
    ds_read_b64_tr_b16 v[38:39], v15 offset:44544
    s_waitcnt lgkmcnt(10)
    v_mfma_f32_32x32x16_bf16 v[40:55], v[16:19], a[48:51], v[40:55]
    s_add_u32 s25, s20, 20480
    buffer_load_dwordx4 a[80:83], v5, s[8:11], s25 offen offset:0 sc1
    ds_read_b64_tr_b16 v[16:17], v15 offset:15360
    ds_read_b64_tr_b16 v[18:19], v15 offset:15872
    s_waitcnt lgkmcnt(10)
    v_mfma_f32_32x32x16_bf16 v[56:71], a[48:51], v[20:23], v[56:71]
    ds_read_b64_tr_b16 v[20:21], v15 offset:45056
    ds_read_b64_tr_b16 v[22:23], v15 offset:45568
    s_waitcnt lgkmcnt(10)
    v_mfma_f32_32x32x16_bf16 v[40:55], v[24:27], a[52:55], v[40:55]
    buffer_load_dwordx4 a[84:87], v5, s[8:11], s25 offen offset:1024 sc1
    ds_read_b64_tr_b16 v[24:25], v15 offset:16384
    ds_read_b64_tr_b16 v[26:27], v15 offset:16896
    s_waitcnt lgkmcnt(10)
    v_mfma_f32_32x32x16_bf16 v[56:71], a[52:55], v[28:31], v[56:71]
    ds_read_b64_tr_b16 v[28:29], v15 offset:46080
    ds_read_b64_tr_b16 v[30:31], v15 offset:46592
    s_waitcnt lgkmcnt(10)
    v_mfma_f32_32x32x16_bf16 v[40:55], v[32:35], a[56:59], v[40:55]
    buffer_load_dwordx4 a[88:91], v5, s[8:11], s25 offen offset:2048 sc1
    ds_read_b64_tr_b16 v[32:33], v15 offset:17408
    ds_read_b64_tr_b16 v[34:35], v15 offset:17920
    s_waitcnt lgkmcnt(10)
    v_mfma_f32_32x32x16_bf16 v[56:71], a[56:59], v[36:39], v[56:71]
    ds_read_b64_tr_b16 v[36:37], v15 offset:47104
    ds_read_b64_tr_b16 v[38:39], v15 offset:47616
    s_waitcnt lgkmcnt(10)
    v_mfma_f32_32x32x16_bf16 v[40:55], v[16:19], a[60:63], v[40:55]
    buffer_load_dwordx4 a[92:95], v5, s[8:11], s25 offen offset:3072 sc1
    ds_read_b64_tr_b16 v[16:17], v15 offset:18432
    ds_read_b64_tr_b16 v[18:19], v15 offset:18944
    s_waitcnt lgkmcnt(10)
    v_mfma_f32_32x32x16_bf16 v[56:71], a[60:63], v[20:23], v[56:71]
    s_waitcnt vmcnt(4)
    ds_read_b64_tr_b16 v[20:21], v15 offset:48128
    ds_read_b64_tr_b16 v[22:23], v15 offset:48640
    s_waitcnt lgkmcnt(10)
    v_mfma_f32_32x32x16_bf16 v[40:55], v[24:27], a[64:67], v[40:55]
    s_add_u32 s25, s20, 24576
    buffer_load_dwordx4 a[96:99], v5, s[8:11], s25 offen offset:0 sc1
    ds_read_b64_tr_b16 v[24:25], v15 offset:19456
    ds_read_b64_tr_b16 v[26:27], v15 offset:19968
    s_waitcnt lgkmcnt(10)
    v_mfma_f32_32x32x16_bf16 v[56:71], a[64:67], v[28:31], v[56:71]
    ds_read_b64_tr_b16 v[28:29], v15 offset:49152
    ds_read_b64_tr_b16 v[30:31], v15 offset:49664
    s_waitcnt lgkmcnt(10)
    v_mfma_f32_32x32x16_bf16 v[40:55], v[32:35], a[68:71], v[40:55]
    buffer_load_dwordx4 a[100:103], v5, s[8:11], s25 offen offset:1024 sc1
    ds_read_b64_tr_b16 v[32:33], v15 offset:20480
    ds_read_b64_tr_b16 v[34:35], v15 offset:20992
    s_waitcnt lgkmcnt(10)
    v_mfma_f32_32x32x16_bf16 v[56:71], a[68:71], v[36:39], v[56:71]
    ds_read_b64_tr_b16 v[36:37], v15 offset:50176
    ds_read_b64_tr_b16 v[38:39], v15 offset:50688
    s_waitcnt lgkmcnt(10)
    v_mfma_f32_32x32x16_bf16 v[40:55], v[16:19], a[72:75], v[40:55]
    buffer_load_dwordx4 a[104:107], v5, s[8:11], s25 offen offset:2048 sc1
    ds_read_b64_tr_b16 v[16:17], v15 offset:21504
    ds_read_b64_tr_b16 v[18:19], v15 offset:22016
    s_waitcnt lgkmcnt(10)
    v_mfma_f32_32x32x16_bf16 v[56:71], a[72:75], v[20:23], v[56:71]
    ds_read_b64_tr_b16 v[20:21], v15 offset:51200
    ds_read_b64_tr_b16 v[22:23], v15 offset:51712
    s_waitcnt lgkmcnt(10)
    v_mfma_f32_32x32x16_bf16 v[40:55], v[24:27], a[76:79], v[40:55]
    buffer_load_dwordx4 a[108:111], v5, s[8:11], s25 offen offset:3072 sc1
    ds_read_b64_tr_b16 v[24:25], v15 offset:22528
    ds_read_b64_tr_b16 v[26:27], v15 offset:23040
    s_waitcnt lgkmcnt(10)
    v_mfma_f32_32x32x16_bf16 v[56:71], a[76:79], v[28:31], v[56:71]
    s_waitcnt vmcnt(4)
    ds_read_b64_tr_b16 v[28:29], v15 offset:52224
    ds_read_b64_tr_b16 v[30:31], v15 offset:52736
    s_waitcnt lgkmcnt(10)
    v_mfma_f32_32x32x16_bf16 v[40:55], v[32:35], a[80:83], v[40:55]
    ds_read_b64_tr_b16 v[32:33], v15 offset:23552
    ds_read_b64_tr_b16 v[34:35], v15 offset:24064
    s_waitcnt lgkmcnt(10)
    v_mfma_f32_32x32x16_bf16 v[56:71], a[80:83], v[36:39], v[56:71]
    ds_read_b64_tr_b16 v[36:37], v15 offset:53248
    ds_read_b64_tr_b16 v[38:39], v15 offset:53760
    s_waitcnt lgkmcnt(10)
    v_mfma_f32_32x32x16_bf16 v[40:55], v[16:19], a[84:87], v[40:55]
    ds_read_b64_tr_b16 v[16:17], v15 offset:24576
    ds_read_b64_tr_b16 v[18:19], v15 offset:25088
    s_waitcnt lgkmcnt(10)
    v_mfma_f32_32x32x16_bf16 v[56:71], a[84:87], v[20:23], v[56:71]
    ds_read_b64_tr_b16 v[20:21], v15 offset:54272
    ds_read_b64_tr_b16 v[22:23], v15 offset:54784
    s_waitcnt lgkmcnt(10)
    v_mfma_f32_32x32x16_bf16 v[40:55], v[24:27], a[88:91], v[40:55]
    ds_read_b64_tr_b16 v[24:25], v15 offset:25600
    ds_read_b64_tr_b16 v[26:27], v15 offset:26112
    s_waitcnt lgkmcnt(10)
    v_mfma_f32_32x32x16_bf16 v[56:71], a[88:91], v[28:31], v[56:71]
    ds_read_b64_tr_b16 v[28:29], v15 offset:55296
    ds_read_b64_tr_b16 v[30:31], v15 offset:55808
    s_waitcnt lgkmcnt(10)
    v_mfma_f32_32x32x16_bf16 v[40:55], v[32:35], a[92:95], v[40:55]
    ds_read_b64_tr_b16 v[32:33], v15 offset:26624
    ds_read_b64_tr_b16 v[34:35], v15 offset:27136
    s_waitcnt lgkmcnt(10)
    v_mfma_f32_32x32x16_bf16 v[56:71], a[92:95], v[36:39], v[56:71]
    s_waitcnt vmcnt(0)
    ds_read_b64_tr_b16 v[36:37], v15 offset:56320
    ds_read_b64_tr_b16 v[38:39], v15 offset:56832
    s_waitcnt lgkmcnt(10)
    v_mfma_f32_32x32x16_bf16 v[40:55], v[16:19], a[96:99], v[40:55]
    ds_read_b64_tr_b16 v[16:17], v15 offset:27648
    ds_read_b64_tr_b16 v[18:19], v15 offset:28160
    s_waitcnt lgkmcnt(10)
    v_mfma_f32_32x32x16_bf16 v[56:71], a[96:99], v[20:23], v[56:71]
    ds_read_b64_tr_b16 v[20:21], v15 offset:57344
    ds_read_b64_tr_b16 v[22:23], v15 offset:57856
    s_waitcnt lgkmcnt(10)
    v_mfma_f32_32x32x16_bf16 v[40:55], v[24:27], a[100:103], v[40:55]
    s_waitcnt lgkmcnt(8)
    v_mfma_f32_32x32x16_bf16 v[56:71], a[100:103], v[28:31], v[56:71]
    s_waitcnt lgkmcnt(6)
    v_mfma_f32_32x32x16_bf16 v[40:55], v[32:35], a[104:107], v[40:55]
    s_waitcnt lgkmcnt(4)
    v_mfma_f32_32x32x16_bf16 v[56:71], a[104:107], v[36:39], v[56:71]
    s_waitcnt lgkmcnt(2)
    v_mfma_f32_32x32x16_bf16 v[40:55], v[16:19], a[108:111], v[40:55]
    s_waitcnt lgkmcnt(0)
    v_mfma_f32_32x32x16_bf16 v[56:71], a[108:111], v[20:23], v[56:71]
L_qkvA_epiTN:
    s_nop 7
    s_nop 3
    v_fmac_f32 v40, v88, v8
    v_mul_f32 v40, v40, v9
    v_fmac_f32 v41, v89, v8
    v_mul_f32 v41, v41, v9
    v_fmac_f32 v42, v90, v8
    v_mul_f32 v42, v42, v9
    v_fmac_f32 v43, v91, v8
    v_mul_f32 v43, v43, v9
    v_fmac_f32 v44, v92, v8
    v_mul_f32 v44, v44, v9
    v_fmac_f32 v45, v93, v8
    v_mul_f32 v45, v45, v9
    v_fmac_f32 v46, v94, v8
    v_mul_f32 v46, v46, v9
    v_fmac_f32 v47, v95, v8
    v_mul_f32 v47, v47, v9
    v_fmac_f32 v48, v96, v8
    v_mul_f32 v48, v48, v9
    v_fmac_f32 v49, v97, v8
    v_mul_f32 v49, v49, v9
    v_fmac_f32 v50, v98, v8
    v_mul_f32 v50, v50, v9
    v_fmac_f32 v51, v99, v8
    v_mul_f32 v51, v51, v9
    v_fmac_f32 v52, v100, v8
    v_mul_f32 v52, v52, v9
    v_fmac_f32 v53, v101, v8
    v_mul_f32 v53, v53, v9
    v_fmac_f32 v54, v102, v8
    v_mul_f32 v54, v54, v9
    v_fmac_f32 v55, v103, v8
    v_mul_f32 v55, v55, v9
    v_cvt_pk_bf16_f32 v40, v40, v41
    v_cvt_pk_bf16_f32 v41, v42, v43
    v_cvt_pk_bf16_f32 v42, v44, v45
    v_cvt_pk_bf16_f32 v43, v46, v47
    v_cvt_pk_bf16_f32 v44, v48, v49
    v_cvt_pk_bf16_f32 v45, v50, v51
    v_cvt_pk_bf16_f32 v46, v52, v53
    v_cvt_pk_bf16_f32 v47, v54, v55
    v_and_b32 v46, v46, v12
    v_and_b32 v47, v47, v12
    buffer_store_dwordx4 v[40:43], v5, s[8:11], s32 offen sc1
    buffer_store_dwordx4 v[44:47], v5, s[8:11], s32 offen offset:1024 sc1
    s_lshl_b32 s28, s12, 8
    s_add_u32 s28, s28, 0
    v_lshl_add_u32 v10, v3, 3, s28
    ds_write_b64 v10, v[8:9]
    v_lshl_add_u32 v10, v4, 5, s28
    s_waitcnt lgkmcnt(0)
    ds_read_b128 v[16:19], v10 offset:0
    ds_read_b128 v[20:23], v10 offset:16
    ds_read_b128 v[24:27], v10 offset:64
    ds_read_b128 v[28:31], v10 offset:80
    ds_read_b128 v[32:35], v10 offset:128
    ds_read_b128 v[36:39], v10 offset:144
    ds_read_b128 v[88:91], v10 offset:192
    ds_read_b128 v[92:95], v10 offset:208
    v_cmp_gt_u32 vcc, 28, v3
    s_nop 1
    v_cndmask_b32 v14, 0, -1, vcc
    v_mov_b32 v11, 0x3f803f80
    v_cmp_eq_u32 vcc, 28, v3
    s_nop 1
    v_cndmask_b32 v13, 0, v11, vcc
    s_waitcnt lgkmcnt(0)
    v_fmac_f32 v56, v104, v16
    v_mul_f32 v56, v56, v17
    v_fmac_f32 v57, v104, v18
    v_mul_f32 v57, v57, v19
    v_fmac_f32 v58, v104, v20
    v_mul_f32 v58, v58, v21
    v_fmac_f32 v59, v104, v22
    v_mul_f32 v59, v59, v23
    v_fmac_f32 v60, v104, v24
    v_mul_f32 v60, v60, v25
    v_fmac_f32 v61, v104, v26
    v_mul_f32 v61, v61, v27
    v_fmac_f32 v62, v104, v28
    v_mul_f32 v62, v62, v29
    v_fmac_f32 v63, v104, v30
    v_mul_f32 v63, v63, v31
    v_fmac_f32 v64, v104, v32
    v_mul_f32 v64, v64, v33
    v_fmac_f32 v65, v104, v34
    v_mul_f32 v65, v65, v35
    v_fmac_f32 v66, v104, v36
    v_mul_f32 v66, v66, v37
    v_fmac_f32 v67, v104, v38
    v_mul_f32 v67, v67, v39
    v_fmac_f32 v68, v104, v88
    v_mul_f32 v68, v68, v89
    v_fmac_f32 v69, v104, v90
    v_mul_f32 v69, v69, v91
    v_fmac_f32 v70, v104, v92
    v_mul_f32 v70, v70, v93
    v_fmac_f32 v71, v104, v94
    v_mul_f32 v71, v71, v95
    v_cvt_pk_bf16_f32 v56, v56, v57
    v_and_or_b32 v56, v56, v14, v13
    v_cvt_pk_bf16_f32 v57, v58, v59
    v_and_or_b32 v57, v57, v14, v13
    v_cvt_pk_bf16_f32 v58, v60, v61
    v_and_or_b32 v58, v58, v14, v13
    v_cvt_pk_bf16_f32 v59, v62, v63
    v_and_or_b32 v59, v59, v14, v13
    v_cvt_pk_bf16_f32 v60, v64, v65
    v_and_or_b32 v60, v60, v14, v13
    v_cvt_pk_bf16_f32 v61, v66, v67
    v_and_or_b32 v61, v61, v14, v13
    v_cvt_pk_bf16_f32 v62, v68, v69
    v_and_or_b32 v62, v62, v14, v13
    v_cvt_pk_bf16_f32 v63, v70, v71
    v_and_or_b32 v63, v63, v14, v13
    buffer_store_dwordx4 v[56:59], v5, s[8:11], s33 offen sc1
    buffer_store_dwordx4 v[60:63], v5, s[8:11], s33 offen offset:1024 sc1
    s_branch L_qkvA_drain
L_qkvA_epiTT:
    s_nop 7
    s_nop 3
    v_fmac_f32 v40, v88, v8
    v_mul_f32 v40, v40, v14
    v_fmac_f32 v41, v89, v8
    v_mul_f32 v41, v41, v14
    v_fmac_f32 v42, v90, v8
    v_mul_f32 v42, v42, v14
    v_fmac_f32 v43, v91, v8
    v_mul_f32 v43, v43, v14
    v_fmac_f32 v44, v92, v8
    v_mul_f32 v44, v44, v14
    v_fmac_f32 v45, v93, v8
    v_mul_f32 v45, v45, v14
    v_fmac_f32 v46, v94, v8
    v_mul_f32 v46, v46, v14
    v_fmac_f32 v47, v95, v8
    v_mul_f32 v47, v47, v14
    v_fmac_f32 v48, v96, v8
    v_mul_f32 v48, v48, v14
    v_fmac_f32 v49, v97, v8
    v_mul_f32 v49, v49, v14
    v_fmac_f32 v50, v98, v8
    v_mul_f32 v50, v50, v14
    v_fmac_f32 v51, v99, v8
    v_mul_f32 v51, v51, v14
    v_fmac_f32 v52, v100, v8
    v_mul_f32 v52, v52, v14
    v_fmac_f32 v53, v101, v8
    v_mul_f32 v53, v53, v14
    v_fmac_f32 v54, v102, v8
    v_mul_f32 v54, v54, v14
    v_fmac_f32 v55, v103, v8
    v_mul_f32 v55, v55, v14
    v_cvt_pk_bf16_f32 v40, v40, v41
    v_cvt_pk_bf16_f32 v41, v42, v43
    v_cvt_pk_bf16_f32 v42, v44, v45
    v_cvt_pk_bf16_f32 v43, v46, v47
    v_cvt_pk_bf16_f32 v44, v48, v49
    v_cvt_pk_bf16_f32 v45, v50, v51
    v_cvt_pk_bf16_f32 v46, v52, v53
    v_cvt_pk_bf16_f32 v47, v54, v55
    v_and_b32 v46, v46, v12
    v_and_b32 v47, v47, v12
    buffer_store_dwordx4 v[40:43], v5, s[8:11], s32 offen sc1
    buffer_store_dwordx4 v[44:47], v5, s[8:11], s32 offen offset:1024 sc1
    v_fmac_f32 v56, v104, v8
    v_mul_f32 v56, v56, v14
    v_fmac_f32 v57, v105, v8
    v_mul_f32 v57, v57, v14
    v_fmac_f32 v58, v106, v8
    v_mul_f32 v58, v58, v14
    v_fmac_f32 v59, v107, v8
    v_mul_f32 v59, v59, v14
    v_fmac_f32 v60, v108, v8
    v_mul_f32 v60, v60, v14
    v_fmac_f32 v61, v109, v8
    v_mul_f32 v61, v61, v14
    v_fmac_f32 v62, v110, v8
    v_mul_f32 v62, v62, v14
    v_fmac_f32 v63, v111, v8
    v_mul_f32 v63, v63, v14
    v_fmac_f32 v64, v112, v8
    v_mul_f32 v64, v64, v14
    v_fmac_f32 v65, v113, v8
    v_mul_f32 v65, v65, v14
    v_fmac_f32 v66, v114, v8
    v_mul_f32 v66, v66, v14
    v_fmac_f32 v67, v115, v8
    v_mul_f32 v67, v67, v14
    v_fmac_f32 v68, v116, v8
    v_mul_f32 v68, v68, v14
    v_fmac_f32 v69, v117, v8
    v_mul_f32 v69, v69, v14
    v_fmac_f32 v70, v118, v8
    v_mul_f32 v70, v70, v14
    v_fmac_f32 v71, v119, v8
    v_mul_f32 v71, v71, v14
    v_cvt_pk_bf16_f32 v56, v56, v57
    v_cvt_pk_bf16_f32 v57, v58, v59
    v_cvt_pk_bf16_f32 v58, v60, v61
    v_cvt_pk_bf16_f32 v59, v62, v63
    v_cvt_pk_bf16_f32 v60, v64, v65
    v_cvt_pk_bf16_f32 v61, v66, v67
    v_cvt_pk_bf16_f32 v62, v68, v69
    v_cvt_pk_bf16_f32 v63, v70, v71
    v_and_b32 v62, v62, v12
    v_and_b32 v63, v63, v12
    buffer_store_dwordx4 v[56:59], v5, s[8:11], s33 offen sc1
    buffer_store_dwordx4 v[60:63], v5, s[8:11], s33 offen offset:1024 sc1
L_qkvA_drain:
    s_waitcnt vmcnt(0)
L_qkvA_sig:
    s_mul_i32 s19, s16, 9
    s_add_u32 s19, s19, s17
    s_barrier
    s_cmp_lg_u32 s12, 0
    s_cbranch_scc1 Lsqa_mega_3
    s_lshl_b32 s58, s19, 7
    s_add_u32 s58, s58, s61
    s_add_u32 s58, s58, 0
    v_mov_b32 v125, 0
    v_mov_b32 v126, s66
    v_mov_b32 v127, s67
    s_mov_b64 exec, 1
    buffer_store_dwordx2 v[126:127], v125, s[8:11], s58 offen sc1
    s_mov_b64 exec, -1
Lsqa_mega_3:
L_qkvA_end:
    s_cmp_lg_u32 s62, 0
    s_cbranch_scc1 L_pair_att2
L_pair_att:
    s_getreg_b32 s69, hwreg(HW_REG_XCC_ID, 0, 4)
    s_xor_b32 s69, s69, s67
    v_lshlrev_b32 v11, 7, v3
    s_lshl_b32 s58, s13, 12
    s_add_u32 s58, s58, 0x3e0000
    s_mov_b32 s59, 0
    s_mov_b32 s68, 0
L_xcc:
    buffer_load_dwordx2 v[12:13], v11, s[8:11], s58 offen sc1
    s_add_u32 s59, s59, 1
    s_waitcnt vmcnt(0)
    v_xor_b32 v10, s67, v13
    v_cmp_ne_u32 vcc, s66, v12
    v_cmp_lt_u32 s[56:57], 15, v10
    s_nop 1
    s_or_b64 vcc, vcc, s[56:57]
    s_cmp_ge_u32 s59, 0x8000
    s_cbranch_scc1 L_xcc_x
    s_cmp_lg_u64 vcc, 0
    s_cbranch_scc1 L_xcc
    v_cmp_ne_u32 vcc, s69, v13
    s_nop 1
    s_cmp_eq_u64 vcc, 0
    s_cselect_b32 s68, 1, 0
L_xcc_x:
L_pair_att2:
    s_lshr_b32 s20, s14, 2
    s_lshl_b32 s21, s13, 3
    s_add_u32 s20, s20, s21
    s_and_b32 s21, s14, 3
    s_lshr_b32 s22, s20, 2
    s_and_b32 s33, s12, 1
    s_lshr_b32 s34, s12, 1
    s_lshl_b32 s15, s20, 4
    s_lshl_b32 s16, s21, 2
    s_add_u32 s15, s15, s16
    s_lshl_b32 s16, s33, 1
    s_add_u32 s15, s15, s16
    s_lshl_b32 s16, s15, 11
    s_add_u32 s16, s16, s60
    s_add_u32 s17, s16, 0x800000
    s_add_u32 s16, s16, 0x200000
    s_lshl_b32 s19, s62, 19
    s_add_u32 s19, s19, s60
    s_add_u32 s19, s19, 0xa00000
    s_lshl_b32 s18, s34, 16
    s_add_u32 s18, s18, s19
    s_mov_b32 s30, 0
    s_cmp_lg_u32 s12, 1
    s_cbranch_scc1 Lwaa_mega_4_n1
    s_lshr_b32 s56, s14, 1
    s_min_u32 s57, s56, 8
    s_lshl_b32 s57, s57, 1
    v_mov_b32 v11, s57
    s_add_u32 s57, s57, 1
    v_writelane_b32 v11, s57, 1
    s_min_u32 s57, s56, 13
    s_add_u32 s57, s57, 66
    v_writelane_b32 v11, s57, 2
    s_add_u32 s57, s57, 14
    v_writelane_b32 v11, s57, 3
    s_mul_i32 s57, s56, 3
    s_add_u32 s57, s57, 18
    v_writelane_b32 v11, s57, 4
    s_add_u32 s57, s57, 1
    v_writelane_b32 v11, s57, 5
    s_add_u32 s57, s57, 1
    v_writelane_b32 v11, s57, 6
    v_lshlrev_b32 v11, 7, v11
    s_mov_b32 s58, 0x300000
    s_mov_b32 s59, 0
Lwaa_mega_4b:
    buffer_load_dwordx2 v[12:13], v11, s[8:11], s58 offen sc1
    s_add_u32 s59, s59, 1
    s_waitcnt vmcnt(0)
    v_cmp_ne_u64 vcc, s[66:67], v[12:13]
    s_cmp_ge_u32 s59, 0x8000
    s_cbranch_scc1 Lwaa_mega_4b_t
    s_nop 0
    s_cbranch_vccnz Lwaa_mega_4b
Lwaa_mega_4b_t:
Lwaa_mega_4_n1:
    s_cmp_lg_u32 s12, 0
    s_cbranch_scc1 Lwaa_mega_4_skip
    v_min_u32 v11, 15, v2
    v_mul_u32_u24 v11, 9, v11
    v_add_u32 v11, 8, v11
    s_mul_i32 s58, s22, 9
    s_lshl_b32 s57, s21, 1
    s_add_u32 s58, s58, s57
    v_writelane_b32 v11, s58, 16
    s_add_u32 s58, s58, 1
    v_writelane_b32 v11, s58, 17
    v_lshlrev_b32 v11, 7, v11
    s_add_u32 s58, s61, 0
    s_mov_b32 s59, 0
Lwaa_mega_4:
    buffer_load_dwordx2 v[12:13], v11, s[8:11], s58 offen sc1
    s_add_u32 s59, s59, 1
    s_waitcnt vmcnt(0)
    v_cmp_ne_u64 vcc, s[66:67], v[12:13]
    s_cmp_ge_u32 s59, 0x8000
    s_cbranch_scc1 Lwaa_mega_4_t
    s_nop 0
    s_cbranch_vccnz Lwaa_mega_4
Lwaa_mega_4_t:
Lwaa_mega_4_skip:
    s_waitcnt vmcnt(0)
    s_barrier
    buffer_load_dwordx4 a[0:3], v5, s[8:11], s16 offen offset:0 sc1
    buffer_load_dwordx4 a[4:7], v5, s[8:11], s16 offen offset:1024 sc1
    buffer_load_dwordx4 a[8:11], v5, s[8:11], s16 offen offset:2048 sc1
    buffer_load_dwordx4 a[12:15], v5, s[8:11], s16 offen offset:3072 sc1
    buffer_load_dwordx4 a[80:83], v5, s[8:11], s19 offen
    buffer_load_dwordx4 a[84:87], v5, s[8:11], s19 offen offset:1024
L_attnA_start:
    s_mov_b32 s37, s18
    buffer_load_dwordx4 a[16:19], v5, s[8:11], s37 offen offset:0
    buffer_load_dwordx4 a[20:23], v5, s[8:11], s37 offen offset:1024
    buffer_load_dwordx4 a[24:27], v5, s[8:11], s37 offen offset:2048
    buffer_load_dwordx4 a[28:31], v5, s[8:11], s37 offen offset:3072
    s_add_u32 s37, s37, 4096
    buffer_load_dwordx4 a[32:35], v5, s[8:11], s37 offen offset:0
    buffer_load_dwordx4 a[36:39], v5, s[8:11], s37 offen offset:1024
    buffer_load_dwordx4 a[40:43], v5, s[8:11], s37 offen offset:2048
    buffer_load_dwordx4 a[44:47], v5, s[8:11], s37 offen offset:3072
    s_add_u32 s37, s37, 4096
    buffer_load_dwordx4 a[48:51], v5, s[8:11], s37 offen offset:0
    buffer_load_dwordx4 a[52:55], v5, s[8:11], s37 offen offset:1024
    buffer_load_dwordx4 a[56:59], v5, s[8:11], s37 offen offset:2048
    buffer_load_dwordx4 a[60:63], v5, s[8:11], s37 offen offset:3072
    s_add_u32 s37, s37, 4096
    v_mov_b32 v56, 0
    v_mov_b32 v57, 0
    v_mov_b32 v58, 0
    v_mov_b32 v59, 0
    v_mov_b32 v60, 0
    v_mov_b32 v61, 0
    v_mov_b32 v62, 0
    v_mov_b32 v63, 0
    v_mov_b32 v64, 0
    v_mov_b32 v65, 0
    v_mov_b32 v66, 0
    v_mov_b32 v67, 0
    v_mov_b32 v68, 0
    v_mov_b32 v69, 0
    v_mov_b32 v70, 0
    v_mov_b32 v71, 0
    v_mov_b32 v72, 0
    v_mov_b32 v73, 0
    v_mov_b32 v74, 0
    v_mov_b32 v75, 0
    v_mov_b32 v76, 0
    v_mov_b32 v77, 0
    v_mov_b32 v78, 0
    v_mov_b32 v79, 0
    v_mov_b32 v80, 0
    v_mov_b32 v81, 0
    v_mov_b32 v82, 0
    v_mov_b32 v83, 0
    v_mov_b32 v84, 0
    v_mov_b32 v85, 0
    v_mov_b32 v86, 0
    v_mov_b32 v87, 0
    v_mov_b32 v52, 0
    v_accvgpr_write_b32 a76, 0
    v_mov_b32 v53, 0
    v_accvgpr_write_b32 a77, 0
    v_mov_b32 v54, 0
    v_accvgpr_write_b32 a78, 0
    v_mov_b32 v55, 0
    v_accvgpr_write_b32 a79, 0
    s_cmp_lg_u32 s30, 0
    s_cbranch_scc1 L_attnA_havemax
    s_waitcnt vmcnt(12)
    v_mfma_f32_32x32x16_bf16 v[16:31], a[80:83], a[0:3], 0
    v_mfma_f32_32x32x16_bf16 v[16:31], a[84:87], a[4:7], v[16:31]
    v_mfma_f32_32x32x16_bf16 v[32:47], a[80:83], a[8:11], 0
    v_mfma_f32_32x32x16_bf16 v[32:47], a[84:87], a[12:15], v[32:47]
    s_nop 9
    v_max3_f32 v120, v16, v17, v18
    v_max3_f32 v120, v120, v19, v20
    v_max3_f32 v120, v120, v21, v22
    v_max3_f32 v120, v120, v23, v24
    v_max3_f32 v120, v120, v25, v26
    v_max3_f32 v120, v120, v27, v28
    v_max3_f32 v120, v120, v29, v30
    v_max_f32 v120, v120, v31
    v_max3_f32 v122, v32, v33, v34
    v_max3_f32 v122, v122, v35, v36
    v_max3_f32 v122, v122, v37, v38
    v_max3_f32 v122, v122, v39, v40
    v_max3_f32 v122, v122, v41, v42
    v_max3_f32 v122, v122, v43, v44
    v_max3_f32 v122, v122, v45, v46
    v_max_f32 v122, v122, v47
    v_mov_b32 v121, v120
    s_nop 1
    v_permlane32_swap_b32 v120, v121
    v_max_f32 v120, v120, v121
    v_mov_b32 v123, v122
    s_nop 1
    v_permlane32_swap_b32 v122, v123
    v_max_f32 v122, v122, v123
L_attnA_havemax:
    v_sub_f32 v88, 0, v120
    v_sub_f32 v104, 0, v122
    v_sub_f32 v89, 0, v120
    v_sub_f32 v105, 0, v122
    v_sub_f32 v90, 0, v120
    v_sub_f32 v106, 0, v122
    v_sub_f32 v91, 0, v120
    v_sub_f32 v107, 0, v122
    v_sub_f32 v92, 0, v120
    v_sub_f32 v108, 0, v122
    v_sub_f32 v93, 0, v120
    v_sub_f32 v109, 0, v122
    v_sub_f32 v94, 0, v120
    v_sub_f32 v110, 0, v122
    v_sub_f32 v95, 0, v120
    v_sub_f32 v111, 0, v122
    v_sub_f32 v96, 0, v120
    v_sub_f32 v112, 0, v122
    v_sub_f32 v97, 0, v120
    v_sub_f32 v113, 0, v122
    v_sub_f32 v98, 0, v120
    v_sub_f32 v114, 0, v122
    v_sub_f32 v99, 0, v120
    v_sub_f32 v115, 0, v122
    v_sub_f32 v100, 0, v120
    v_sub_f32 v116, 0, v122
    v_sub_f32 v101, 0, v120
    v_sub_f32 v117, 0, v122
    v_sub_f32 v102, 0, v120
    v_sub_f32 v118, 0, v122
    v_sub_f32 v103, 0, v120
    v_sub_f32 v119, 0, v122
    s_waitcnt vmcnt(8)
    v_mfma_f32_32x32x16_bf16 v[16:31], a[16:19], a[0:3], v[88:103]
    v_mfma_f32_32x32x16_bf16 v[16:31], a[20:23], a[4:7], v[16:31]
    s_mov_b32 s23, 0
    s_nop 7
    s_nop 3
    s_cmp_lt_u32 s12, 4
    s_cbranch_scc1 L_attnA_loop
    s_setprio 1
L_attnA_loop:
    v_exp_f32 v16, v16
    v_exp_f32 v17, v17
    v_mfma_f32_32x32x16_bf16 v[72:87], a[76:79], v[52:55], v[72:87]
    v_exp_f32 v18, v18
    v_exp_f32 v19, v19
    v_cvt_pk_bf16_f32 v48, v16, v17
    v_cvt_pk_bf16_f32 v49, v18, v19
    v_mfma_f32_32x32x16_bf16 v[32:47], a[16:19], a[8:11], v[104:119]
    v_exp_f32 v20, v20
    v_exp_f32 v21, v21
    v_exp_f32 v22, v22
    v_exp_f32 v23, v23
    v_cvt_pk_bf16_f32 v50, v20, v21
    v_cvt_pk_bf16_f32 v51, v22, v23
    v_mfma_f32_32x32x16_bf16 v[32:47], a[20:23], a[12:15], v[32:47]
    v_exp_f32 v24, v24
    v_exp_f32 v25, v25
    v_exp_f32 v26, v26
    v_exp_f32 v27, v27
    v_cvt_pk_bf16_f32 v52, v24, v25
    v_cvt_pk_bf16_f32 v53, v26, v27
    v_mfma_f32_32x32x16_bf16 v[56:71], a[24:27], v[48:51], v[56:71]
    v_exp_f32 v28, v28
    v_exp_f32 v29, v29
    v_exp_f32 v30, v30
    v_exp_f32 v31, v31
    v_cvt_pk_bf16_f32 v54, v28, v29
    v_cvt_pk_bf16_f32 v55, v30, v31
    v_exp_f32 v32, v32
    v_exp_f32 v33, v33
    v_mfma_f32_32x32x16_bf16 v[56:71], a[28:31], v[52:55], v[56:71]
    s_waitcnt vmcnt(4)
    v_exp_f32 v34, v34
    v_exp_f32 v35, v35
    v_cvt_pk_bf16_f32 v48, v32, v33
    v_cvt_pk_bf16_f32 v49, v34, v35
    v_mfma_f32_32x32x16_bf16 v[16:31], a[32:35], a[0:3], v[88:103]
    buffer_load_dwordx4 a[64:67], v5, s[8:11], s37 offen offset:0
    buffer_load_dwordx4 a[68:71], v5, s[8:11], s37 offen offset:1024
    buffer_load_dwordx4 a[72:75], v5, s[8:11], s37 offen offset:2048
    buffer_load_dwordx4 a[76:79], v5, s[8:11], s37 offen offset:3072
    s_add_u32 s37, s37, 4096
    v_exp_f32 v36, v36
    v_exp_f32 v37, v37
    v_exp_f32 v38, v38
    v_exp_f32 v39, v39
    v_cvt_pk_bf16_f32 v50, v36, v37
    v_cvt_pk_bf16_f32 v51, v38, v39
    v_mfma_f32_32x32x16_bf16 v[16:31], a[36:39], a[4:7], v[16:31]
    v_exp_f32 v40, v40
    v_exp_f32 v41, v41
    v_exp_f32 v42, v42
    v_exp_f32 v43, v43
    v_cvt_pk_bf16_f32 v52, v40, v41
    v_cvt_pk_bf16_f32 v53, v42, v43
    v_mfma_f32_32x32x16_bf16 v[72:87], a[24:27], v[48:51], v[72:87]
    v_exp_f32 v44, v44
    v_exp_f32 v45, v45
    v_exp_f32 v46, v46
    v_exp_f32 v47, v47
    v_cvt_pk_bf16_f32 v54, v44, v45
    v_cvt_pk_bf16_f32 v55, v46, v47
    v_exp_f32 v16, v16
    v_exp_f32 v17, v17
    v_mfma_f32_32x32x16_bf16 v[72:87], a[28:31], v[52:55], v[72:87]
    v_exp_f32 v18, v18
    v_exp_f32 v19, v19
    v_cvt_pk_bf16_f32 v48, v16, v17
    v_cvt_pk_bf16_f32 v49, v18, v19
    v_mfma_f32_32x32x16_bf16 v[32:47], a[32:35], a[8:11], v[104:119]
    v_exp_f32 v20, v20
    v_exp_f32 v21, v21
    v_exp_f32 v22, v22
    v_exp_f32 v23, v23
    v_cvt_pk_bf16_f32 v50, v20, v21
    v_cvt_pk_bf16_f32 v51, v22, v23
    v_mfma_f32_32x32x16_bf16 v[32:47], a[36:39], a[12:15], v[32:47]
    v_exp_f32 v24, v24
    v_exp_f32 v25, v25
    v_exp_f32 v26, v26
    v_exp_f32 v27, v27
    v_cvt_pk_bf16_f32 v52, v24, v25
    v_cvt_pk_bf16_f32 v53, v26, v27
    v_mfma_f32_32x32x16_bf16 v[56:71], a[40:43], v[48:51], v[56:71]
    v_exp_f32 v28, v28
    v_exp_f32 v29, v29
    v_exp_f32 v30, v30
    v_exp_f32 v31, v31
    v_cvt_pk_bf16_f32 v54, v28, v29
    v_cvt_pk_bf16_f32 v55, v30, v31
    v_exp_f32 v32, v32
    v_exp_f32 v33, v33
    v_mfma_f32_32x32x16_bf16 v[56:71], a[44:47], v[52:55], v[56:71]
    s_waitcnt vmcnt(4)
    v_exp_f32 v34, v34
    v_exp_f32 v35, v35
    v_cvt_pk_bf16_f32 v48, v32, v33
    v_cvt_pk_bf16_f32 v49, v34, v35
    v_mfma_f32_32x32x16_bf16 v[16:31], a[48:51], a[0:3], v[88:103]
    buffer_load_dwordx4 a[16:19], v5, s[8:11], s37 offen offset:0
    buffer_load_dwordx4 a[20:23], v5, s[8:11], s37 offen offset:1024
    buffer_load_dwordx4 a[24:27], v5, s[8:11], s37 offen offset:2048
    buffer_load_dwordx4 a[28:31], v5, s[8:11], s37 offen offset:3072
    s_add_u32 s37, s37, 4096
    v_exp_f32 v36, v36
    v_exp_f32 v37, v37
    v_exp_f32 v38, v38
    v_exp_f32 v39, v39
    v_cvt_pk_bf16_f32 v50, v36, v37
    v_cvt_pk_bf16_f32 v51, v38, v39
    v_mfma_f32_32x32x16_bf16 v[16:31], a[52:55], a[4:7], v[16:31]
    v_exp_f32 v40, v40
    v_exp_f32 v41, v41
    v_exp_f32 v42, v42
    v_exp_f32 v43, v43
    v_cvt_pk_bf16_f32 v52, v40, v41
    v_cvt_pk_bf16_f32 v53, v42, v43
    v_mfma_f32_32x32x16_bf16 v[72:87], a[40:43], v[48:51], v[72:87]
    v_exp_f32 v44, v44
    v_exp_f32 v45, v45
    v_exp_f32 v46, v46
    v_exp_f32 v47, v47
    v_cvt_pk_bf16_f32 v54, v44, v45
    v_cvt_pk_bf16_f32 v55, v46, v47
    v_exp_f32 v16, v16
    v_exp_f32 v17, v17
    v_mfma_f32_32x32x16_bf16 v[72:87], a[44:47], v[52:55], v[72:87]
    v_exp_f32 v18, v18
    v_exp_f32 v19, v19
    v_cvt_pk_bf16_f32 v48, v16, v17
    v_cvt_pk_bf16_f32 v49, v18, v19
    v_mfma_f32_32x32x16_bf16 v[32:47], a[48:51], a[8:11], v[104:119]
    v_exp_f32 v20, v20
    v_exp_f32 v21, v21
    v_exp_f32 v22, v22
    v_exp_f32 v23, v23
    v_cvt_pk_bf16_f32 v50, v20, v21
    v_cvt_pk_bf16_f32 v51, v22, v23
    v_mfma_f32_32x32x16_bf16 v[32:47], a[52:55], a[12:15], v[32:47]
    v_exp_f32 v24, v24
    v_exp_f32 v25, v25
    v_exp_f32 v26, v26
    v_exp_f32 v27, v27
    v_cvt_pk_bf16_f32 v52, v24, v25
    v_cvt_pk_bf16_f32 v53, v26, v27
    v_mfma_f32_32x32x16_bf16 v[56:71], a[56:59], v[48:51], v[56:71]
    v_exp_f32 v28, v28
    v_exp_f32 v29, v29
    v_exp_f32 v30, v30
    v_exp_f32 v31, v31
    v_cvt_pk_bf16_f32 v54, v28, v29
    v_cvt_pk_bf16_f32 v55, v30, v31
    v_exp_f32 v32, v32
    v_exp_f32 v33, v33
    v_mfma_f32_32x32x16_bf16 v[56:71], a[60:63], v[52:55], v[56:71]
    s_waitcnt vmcnt(4)
    v_exp_f32 v34, v34
    v_exp_f32 v35, v35
    v_cvt_pk_bf16_f32 v48, v32, v33
    v_cvt_pk_bf16_f32 v49, v34, v35
    v_mfma_f32_32x32x16_bf16 v[16:31], a[64:67], a[0:3], v[88:103]
    buffer_load_dwordx4 a[32:35], v5, s[8:11], s37 offen offset:0
    buffer_load_dwordx4 a[36:39], v5, s[8:11], s37 offen offset:1024
    buffer_load_dwordx4 a[40:43], v5, s[8:11], s37 offen offset:2048
    buffer_load_dwordx4 a[44:47], v5, s[8:11], s37 offen offset:3072
    s_add_u32 s37, s37, 4096
    v_exp_f32 v36, v36
    v_exp_f32 v37, v37
    v_exp_f32 v38, v38
    v_exp_f32 v39, v39
    v_cvt_pk_bf16_f32 v50, v36, v37
    v_cvt_pk_bf16_f32 v51, v38, v39
    v_mfma_f32_32x32x16_bf16 v[16:31], a[68:71], a[4:7], v[16:31]
    v_exp_f32 v40, v40
    v_exp_f32 v41, v41
    v_exp_f32 v42, v42
    v_exp_f32 v43, v43
    v_cvt_pk_bf16_f32 v52, v40, v41
    v_cvt_pk_bf16_f32 v53, v42, v43
    v_mfma_f32_32x32x16_bf16 v[72:87], a[56:59], v[48:51], v[72:87]
    v_exp_f32 v44, v44
    v_exp_f32 v45, v45
    v_exp_f32 v46, v46
    v_exp_f32 v47, v47
    v_cvt_pk_bf16_f32 v54, v44, v45
    v_cvt_pk_bf16_f32 v55, v46, v47
    v_exp_f32 v16, v16
    v_exp_f32 v17, v17
    v_mfma_f32_32x32x16_bf16 v[72:87], a[60:63], v[52:55], v[72:87]
    v_exp_f32 v18, v18
    v_exp_f32 v19, v19
    v_cvt_pk_bf16_f32 v48, v16, v17
    v_cvt_pk_bf16_f32 v49, v18, v19
    v_mfma_f32_32x32x16_bf16 v[32:47], a[64:67], a[8:11], v[104:119]
    v_exp_f32 v20, v20
    v_exp_f32 v21, v21
    v_exp_f32 v22, v22
    v_exp_f32 v23, v23
    v_cvt_pk_bf16_f32 v50, v20, v21
    v_cvt_pk_bf16_f32 v51, v22, v23
    v_mfma_f32_32x32x16_bf16 v[32:47], a[68:71], a[12:15], v[32:47]
    v_exp_f32 v24, v24
    v_exp_f32 v25, v25
    v_exp_f32 v26, v26
    v_exp_f32 v27, v27
    v_cvt_pk_bf16_f32 v52, v24, v25
    v_cvt_pk_bf16_f32 v53, v26, v27
    v_mfma_f32_32x32x16_bf16 v[56:71], a[72:75], v[48:51], v[56:71]
    v_exp_f32 v28, v28
    v_exp_f32 v29, v29
    v_exp_f32 v30, v30
    v_exp_f32 v31, v31
    v_cvt_pk_bf16_f32 v54, v28, v29
    v_cvt_pk_bf16_f32 v55, v30, v31
    v_exp_f32 v32, v32
    v_exp_f32 v33, v33
    v_mfma_f32_32x32x16_bf16 v[56:71], a[76:79], v[52:55], v[56:71]
    s_waitcnt vmcnt(4)
    v_exp_f32 v34, v34
    v_exp_f32 v35, v35
    v_cvt_pk_bf16_f32 v48, v32, v33
    v_cvt_pk_bf16_f32 v49, v34, v35
    v_mfma_f32_32x32x16_bf16 v[16:31], a[16:19], a[0:3], v[88:103]
    buffer_load_dwordx4 a[48:51], v5, s[8:11], s37 offen offset:0
    buffer_load_dwordx4 a[52:55], v5, s[8:11], s37 offen offset:1024
    buffer_load_dwordx4 a[56:59], v5, s[8:11], s37 offen offset:2048
    buffer_load_dwordx4 a[60:63], v5, s[8:11], s37 offen offset:3072
    s_add_u32 s37, s37, 4096
    v_exp_f32 v36, v36
    v_exp_f32 v37, v37
    v_exp_f32 v38, v38
    v_exp_f32 v39, v39
    v_cvt_pk_bf16_f32 v50, v36, v37
    v_cvt_pk_bf16_f32 v51, v38, v39
    v_mfma_f32_32x32x16_bf16 v[16:31], a[20:23], a[4:7], v[16:31]
    v_exp_f32 v40, v40
    v_exp_f32 v41, v41
    v_exp_f32 v42, v42
    v_exp_f32 v43, v43
    v_cvt_pk_bf16_f32 v52, v40, v41
    v_cvt_pk_bf16_f32 v53, v42, v43
    v_mfma_f32_32x32x16_bf16 v[72:87], a[72:75], v[48:51], v[72:87]
    v_exp_f32 v44, v44
    v_exp_f32 v45, v45
    v_exp_f32 v46, v46
    v_exp_f32 v47, v47
    v_cvt_pk_bf16_f32 v54, v44, v45
    v_cvt_pk_bf16_f32 v55, v46, v47
    s_cmp_ge_u32 s23, 3
    s_cbranch_scc1 L_attnA_pfdone
    s_mov_b32 s39, s21
    s_cmp_eq_u32 s23, 1
    s_cbranch_scc1 L_attnA_pf1
    s_cmp_eq_u32 s23, 2
    s_cbranch_scc1 L_attnA_pf2
    s_lshl_b32 s24, s34, 10
    s_add_u32 s24, s24, s17
    buffer_load_dwordx4 a[80:83], v5, s[8:11], s24 offen sc1
    s_lshr_b32 s24, s14, 1
    s_cmp_ge_u32 s24, 14
    s_cbranch_scc1 L_attnA_pfr
    s_lshl_b32 s21, s24, 15
    s_add_u32 s21, s21, 0x88000
    s_sub_u32 s57, s12, 0
    s_mul_i32 s57, s57, 4096
    s_add_u32 s57, s57, 0
    s_add_u32 s56, s21, s57
    s_add_u32 s57, s57, 131072
    s_add_u32 m0, s57, 0
    s_add_u32 s58, s56, 0
    buffer_load_dwordx4 v5, s[8:11], s58 offen offset:0 sc1 lds
    buffer_load_dwordx4 v5, s[8:11], s58 offen offset:1024 sc1 lds
    buffer_load_dwordx4 v5, s[8:11], s58 offen offset:2048 sc1 lds
    buffer_load_dwordx4 v5, s[8:11], s58 offen offset:3072 sc1 lds
    s_branch L_attnA_pfr
L_attnA_pf1:
    s_lshr_b32 s24, s14, 1
    s_mul_i32 s21, s24, 89088
    s_add_u32 s21, s21, 0x100000
    s_sub_u32 s57, s12, 0
    s_mul_i32 s57, s57, 5120
    s_add_u32 s57, s57, 0
    s_add_u32 s56, s21, s57
    s_add_u32 s57, s57, 16384
    s_add_u32 m0, s57, 0
    s_add_u32 s58, s56, 0
    buffer_load_dwordx4 v5, s[8:11], s58 offen offset:0 sc1 lds
    buffer_load_dwordx4 v5, s[8:11], s58 offen offset:1024 sc1 lds
    buffer_load_dwordx4 v5, s[8:11], s58 offen offset:2048 sc1 lds
    buffer_load_dwordx4 v5, s[8:11], s58 offen offset:3072 sc1 lds
    s_add_u32 m0, s57, 4096
    s_add_u32 s58, s56, 4096
    buffer_load_dwordx4 v5, s[8:11], s58 offen offset:0 sc1 lds
    s_branch L_attnA_pfr
L_attnA_pf2:
    s_lshr_b32 s24, s14, 1
    s_mul_i32 s21, s24, 89088
    s_add_u32 s21, s21, 0x100000
    s_sub_u32 s57, s12, 0
    s_mul_i32 s57, s57, 5120
    s_add_u32 s57, s57, 40960
    s_add_u32 s56, s21, s57
    s_add_u32 s57, s57, 16384
    s_add_u32 m0, s57, 0
    s_add_u32 s58, s56, 0
    buffer_load_dwordx4 v5, s[8:11], s58 offen offset:0 sc1 lds
    buffer_load_dwordx4 v5, s[8:11], s58 offen offset:1024 sc1 lds
    buffer_load_dwordx4 v5, s[8:11], s58 offen offset:2048 sc1 lds
    buffer_load_dwordx4 v5, s[8:11], s58 offen offset:3072 sc1 lds
    s_cmp_eq_u32 s12, 7
    s_cbranch_scc1 Lpfs_mega_5
    s_add_u32 m0, s57, 4096
    s_add_u32 s58, s56, 4096
    buffer_load_dwordx4 v5, s[8:11], s58 offen offset:0 sc1 lds
Lpfs_mega_5:
L_attnA_pfr:
    s_mov_b32 s21, s39
L_attnA_pfdone:
    s_add_u32 s23, s23, 1
    s_cmp_lt_u32 s23, 4
    s_cbranch_scc1 L_attnA_loop
    s_setprio 0
    v_mfma_f32_32x32x16_bf16 v[72:87], a[76:79], v[52:55], v[72:87]
    v_mov_b32 v16, 0x52800000
    s_sub_u32 s24, s34, 1
    s_max_i32 s24, s24, 0
    s_lshl_b32 s24, s24, 2
    s_lshl_b32 s25, s33, 1
    s_add_u32 s24, s24, s25
    s_lshl_b32 s24, s24, 12
    s_add_u32 s26, s24, 81920
    s_cmp_lt_u32 s34, 2
    s_cselect_b32 s24, s24, s26
    v_add_u32 v121, s24, v5
    v_cmp_nlt_f32 vcc, v68, v16
    v_cmp_nlt_f32 s[26:27], v84, v16
    s_lshl_b32 s25, s12, 2
    s_add_u32 s25, s25, 97280
    v_mov_b32 v16, s25
    s_or_b32 s26, s27, vcc_hi
    s_cmp_lg_u32 s26, 0
    s_cselect_b32 s25, 1, 0
    v_mov_b32 v17, s25
    s_waitcnt vmcnt(0)
    ds_write_b32 v16, v17
    s_cmp_eq_u32 s34, 0
    s_cbranch_scc1 L_attnA_wb
    ds_write_b128 v121, v[56:59] offset:0
    ds_write_b128 v121, v[60:63] offset:1024
    ds_write_b128 v121, v[64:67] offset:2048
    ds_write_b128 v121, v[68:71] offset:3072
    s_cmp_eq_u32 s34, 1
    s_cbranch_scc1 L_attnA_wdone
L_attnA_wb:
    ds_write_b128 v121, v[72:75] offset:4096
    ds_write_b128 v121, v[76:79] offset:5120
    ds_write_b128 v121, v[80:83] offset:6144
    ds_write_b128 v121, v[84:87] offset:7168
L_attnA_wdone:
    s_waitcnt lgkmcnt(0)
    s_barrier
    s_cmp_ge_u32 s34, 2
    s_cbranch_scc1 L_attnA_novr
    s_lshl_b32 s24, s33, 1
    s_add_u32 s24, s24, s34
    s_lshl_b32 s24, s24, 12
    v_add_u32 v121, s24, v5
    v_add_u32 v123, 98304, v121
    ds_read_b128 v[20:23], v121 offset:0
    ds_read_b128 v[24:27], v121 offset:1024
    ds_read_b128 v[28:31], v121 offset:2048
    ds_read_b128 v[32:35], v121 offset:3072
    ds_read_b128 v[88:91], v123 offset:0
    ds_read_b128 v[92:95], v123 offset:1024
    ds_read_b128 v[96:99], v123 offset:2048
    ds_read_b128 v[100:103], v123 offset:3072
    ds_read_b128 v[104:107], v123 offset:16384
    ds_read_b128 v[108:111], v123 offset:17408
    ds_read_b128 v[112:115], v123 offset:18432
    ds_read_b128 v[116:119], v123 offset:19456
L_attnA_novr:
    v_and_b32 v16, 7, v2
    v_lshlrev_b32 v16, 2, v16
    v_add_u32 v16, 97280, v16
    ds_read_b32 v17, v16
    s_waitcnt lgkmcnt(0)
    v_cmp_ne_u32 vcc, 0, v17
    s_nop 1
    s_or_b32 s25, vcc_lo, vcc_hi
    s_cmp_lg_u32 s25, 0
    s_cbranch_scc1 L_attnA_retry
L_attnA_fin:
    s_cmp_ge_u32 s34, 2
    s_cbranch_scc1 L_attnA_sig
    s_cmp_eq_u32 s34, 0
    s_cbranch_scc1 L_attnA_fa
    s_add_u32 s17, s17, 2048
    v_mov_b32 v56, v72
    v_mov_b32 v57, v73
    v_mov_b32 v58, v74
    v_mov_b32 v59, v75
    v_mov_b32 v60, v76
    v_mov_b32 v61, v77
    v_mov_b32 v62, v78
    v_mov_b32 v63, v79
    v_mov_b32 v64, v80
    v_mov_b32 v65, v81
    v_mov_b32 v66, v82
    v_mov_b32 v67, v83
    v_mov_b32 v68, v84
    v_mov_b32 v69, v85
    v_mov_b32 v70, v86
    v_mov_b32 v71, v87
L_attnA_fa:
    v_add_f32 v88, v88, v104
    v_add_f32 v56, v56, v20
    v_add_f32 v56, v56, v88
    v_add_f32 v89, v89, v105
    v_add_f32 v57, v57, v21
    v_add_f32 v57, v57, v89
    v_add_f32 v90, v90, v106
    v_add_f32 v58, v58, v22
    v_add_f32 v58, v58, v90
    v_add_f32 v91, v91, v107
    v_add_f32 v59, v59, v23
    v_add_f32 v59, v59, v91
    v_add_f32 v92, v92, v108
    v_add_f32 v60, v60, v24
    v_add_f32 v60, v60, v92
    v_add_f32 v93, v93, v109
    v_add_f32 v61, v61, v25
    v_add_f32 v61, v61, v93
    v_add_f32 v94, v94, v110
    v_add_f32 v62, v62, v26
    v_add_f32 v62, v62, v94
    v_add_f32 v95, v95, v111
    v_add_f32 v63, v63, v27
    v_add_f32 v63, v63, v95
    v_add_f32 v96, v96, v112
    v_add_f32 v64, v64, v28
    v_add_f32 v64, v64, v96
    v_add_f32 v97, v97, v113
    v_add_f32 v65, v65, v29
    v_add_f32 v65, v65, v97
    v_add_f32 v98, v98, v114
    v_add_f32 v66, v66, v30
    v_add_f32 v66, v66, v98
    v_add_f32 v99, v99, v115
    v_add_f32 v67, v67, v31
    v_add_f32 v67, v67, v99
    v_add_f32 v100, v100, v116
    v_add_f32 v68, v68, v32
    v_add_f32 v68, v68, v100
    v_add_f32 v101, v101, v117
    v_add_f32 v69, v69, v33
    v_add_f32 v69, v69, v101
    v_add_f32 v102, v102, v118
    v_add_f32 v70, v70, v34
    v_add_f32 v70, v70, v102
    v_add_f32 v103, v103, v119
    v_add_f32 v71, v71, v35
    v_add_f32 v71, v71, v103
    v_mov_b32 v121, v68
    v_mov_b32 v123, v68
    s_nop 1
    v_permlane32_swap_b32 v121, v123
    v_rcp_f32 v123, v123
    v_cmp_eq_u32 vcc, 0, v4
    s_nop 1
    v_cndmask_b32 v121, 0, -1, vcc
    v_mul_f32 v56, v56, v123
    v_mul_f32 v57, v57, v123
    v_mul_f32 v58, v58, v123
    v_mul_f32 v59, v59, v123
    v_mul_f32 v60, v60, v123
    v_mul_f32 v61, v61, v123
    v_mul_f32 v62, v62, v123
    v_mul_f32 v63, v63, v123
    v_mul_f32 v64, v64, v123
    v_mul_f32 v65, v65, v123
    v_mul_f32 v66, v66, v123
    v_mul_f32 v67, v67, v123
    v_mul_f32 v68, v68, v123
    v_mul_f32 v69, v69, v123
    v_mul_f32 v70, v70, v123
    v_mul_f32 v71, v71, v123
    v_cvt_pk_bf16_f32 v48, v56, v57
    v_cvt_pk_bf16_f32 v49, v58, v59
    v_cvt_pk_bf16_f32 v50, v60, v61
    v_cvt_pk_bf16_f32 v51, v62, v63
    v_cvt_pk_bf16_f32 v52, v64, v65
    v_cvt_pk_bf16_f32 v53, v66, v67
    v_cvt_pk_bf16_f32 v54, v68, v69
    v_cvt_pk_bf16_f32 v55, v70, v71
    v_and_b32 v54, v54, v121
    v_and_b32 v55, v55, v121
    s_cmp_lg_u32 s68, 0
    s_cbranch_scc1 Lls_mega_6_loc
    buffer_store_dwordx4 v[48:51], v5, s[8:11], s17 offen sc1
    buffer_store_dwordx4 v[52:55], v5, s[8:11], s17 offen offset:1024 sc1
    s_branch Lls_mega_6_end
Lls_mega_6_loc:
    buffer_store_dwordx4 v[48:51], v5, s[8:11], s17 offen
    buffer_store_dwordx4 v[52:55], v5, s[8:11], s17 offen offset:1024
Lls_mega_6_end:
    s_branch L_attnA_sig
L_attnA_retry:
    s_cmp_lg_u32 s30, 0
    s_cbranch_scc1 L_attnA_fin
    s_mov_b32 s30, 1
    s_mov_b32 s37, s19
    s_mov_b32 s24, 0
    v_mov_b32 v120, 0xff800000
    v_mov_b32 v122, 0xff800000
L_attnA_scanloop:
    buffer_load_dwordx4 a[80:83], v5, s[8:11], s37 offen
    buffer_load_dwordx4 a[84:87], v5, s[8:11], s37 offen offset:1024
    s_waitcnt vmcnt(0)
    v_mfma_f32_32x32x16_bf16 v[16:31], a[80:83], a[0:3], 0
    v_mfma_f32_32x32x16_bf16 v[16:31], a[84:87], a[4:7], v[16:31]
    v_mfma_f32_32x32x16_bf16 v[32:47], a[80:83], a[8:11], 0
    v_mfma_f32_32x32x16_bf16 v[32:47], a[84:87], a[12:15], v[32:47]
    s_nop 9
    v_max3_f32 v120, v120, v16, v17
    v_max3_f32 v120, v120, v18, v19
    v_max3_f32 v120, v120, v20, v21
    v_max3_f32 v120, v120, v22, v23
    v_max3_f32 v120, v120, v24, v25
    v_max3_f32 v120, v120, v26, v27
    v_max3_f32 v120, v120, v28, v29
    v_max3_f32 v120, v120, v30, v31
    v_max3_f32 v122, v122, v32, v33
    v_max3_f32 v122, v122, v34, v35
    v_max3_f32 v122, v122, v36, v37
    v_max3_f32 v122, v122, v38, v39
    v_max3_f32 v122, v122, v40, v41
    v_max3_f32 v122, v122, v42, v43
    v_max3_f32 v122, v122, v44, v45
    v_max3_f32 v122, v122, v46, v47
    s_add_u32 s37, s37, 4096
    s_add_u32 s24, s24, 1
    s_cmp_lt_u32 s24, 64
    s_cbranch_scc1 L_attnA_scanloop
    v_mov_b32 v121, v120
    s_nop 1
    v_permlane32_swap_b32 v120, v121
    v_max_f32 v120, v120, v121
    v_mov_b32 v123, v122
    s_nop 1
    v_permlane32_swap_b32 v122, v123
    v_max_f32 v122, v122, v123
    s_waitcnt lgkmcnt(0)
    s_barrier
    s_branch L_attnA_start
L_attnA_sig:
    s_lshl_b32 s19, s20, 2
    s_add_u32 s19, s19, s21
    s_waitcnt vmcnt(0) lgkmcnt(0)
    s_barrier
    s_cmp_lg_u32 s12, 0
    s_cbranch_scc1 Lsaa_mega_7
    s_lshl_b32 s58, s19, 7
    s_add_u32 s58, s58, s61
    s_add_u32 s58, s58, 65536
    v_mov_b32 v125, 0
    v_mov_b32 v126, s66
    v_mov_b32 v127, s67
    s_mov_b64 exec, 1
    s_cmp_lg_u32 s68, 0
    s_cbranch_scc1 Lls_mega_8_loc
    buffer_store_dwordx2 v[126:127], v125, s[8:11], s58 offen sc1
    s_branch Lls_mega_8_end
Lls_mega_8_loc:
    buffer_store_dwordx2 v[126:127], v125, s[8:11], s58 offen
Lls_mega_8_end:
    s_mov_b64 exec, -1
Lsaa_mega_7:
    s_cmp_lt_u32 s12, 4
    s_cbranch_scc1 L_attnA_end
    s_and_b32 s16, s14, 1
    s_lshl_b32 s15, s13, 1
    s_add_u32 s16, s16, s15
    s_lshr_b32 s17, s14, 1
    s_and_b32 s15, s12, 3
    s_lshl_b32 s18, s16, 2
    s_add_u32 s15, s15, s18
    s_mul_i32 s21, s17, 89088
    s_add_u32 s21, s21, 0x100000
    s_sub_u32 s57, s12, 4
    s_mul_i32 s57, s57, 2048
    s_add_u32 s57, s57, 80896
    s_add_u32 s56, s21, s57
    s_add_u32 s57, s57, 16384
    s_add_u32 m0, s57, 0
    s_add_u32 s58, s56, 0
    buffer_load_dwordx4 v5, s[8:11], s58 offen offset:0 sc1 lds
    buffer_load_dwordx4 v5, s[8:11], s58 offen offset:1024 sc1 lds
L_attnA_end:
    s_and_b32 s16, s14, 1
    s_lshl_b32 s15, s13, 1
    s_add_u32 s16, s16, s15
    s_lshr_b32 s17, s14, 1
    s_and_b32 s15, s12, 3
    s_lshl_b32 s18, s16, 2
    s_add_u32 s15, s15, s18
    s_cmp_ge_u32 s17, 14
    s_cbranch_scc1 L_prjA_end
    s_lshl_b32 s19, s16, 4
    s_lshl_b32 s20, s15, 15
    s_add_u32 s20, s20, s60
    s_add_u32 s20, s20, 0x800000
    s_mul_i32 s30, s15, 28672
    s_lshl_b32 s31, s17, 11
    s_add_u32 s30, s30, s31
    s_add_u32 s30, s30, s60
    s_cmp_lg_u32 s12, 0
    s_cbranch_scc1 LwprjA_mega_9_skip
    v_min_u32 v11, 15, v2
    v_lshlrev_b32 v11, 7, v11
    s_lshl_b32 s58, s19, 7
    s_add_u32 s58, s58, s61
    s_add_u32 s58, s58, 0x10000
    s_mov_b32 s59, 0
LwprjA_mega_9:
    buffer_load_dwordx2 v[12:13], v11, s[8:11], s58 offen sc1
    s_add_u32 s59, s59, 1
    s_waitcnt vmcnt(0)
    v_cmp_ne_u64 vcc, s[66:67], v[12:13]
    s_cmp_ge_u32 s59, 0x8000
    s_cbranch_scc1 LwprjA_mega_9_t
    s_nop 0
    s_cbranch_vccnz LwprjA_mega_9
LwprjA_mega_9_t:
LwprjA_mega_9_skip:
    s_waitcnt vmcnt(0)
    s_barrier
    s_cmp_ge_u32 s12, 4
    s_cbranch_scc1 L_prjA_sig
    s_add_u32 s25, s20, 0
    buffer_load_dwordx4 a[0:3], v5, s[8:11], s25 offen offset:0 sc1
    buffer_load_dwordx4 a[4:7], v5, s[8:11], s25 offen offset:1024 sc1
    buffer_load_dwordx4 a[8:11], v5, s[8:11], s25 offen offset:2048 sc1
    buffer_load_dwordx4 a[12:15], v5, s[8:11], s25 offen offset:3072 sc1
    buffer_load_dwordx4 v[88:91], v5, s[8:11], s30 offen sc1
    buffer_load_dwordx4 v[92:95], v5, s[8:11], s30 offen offset:1024 sc1
    s_add_u32 s25, s20, 4096
    buffer_load_dwordx4 a[16:19], v5, s[8:11], s25 offen offset:0 sc1
    buffer_load_dwordx4 a[20:23], v5, s[8:11], s25 offen offset:1024 sc1
    buffer_load_dwordx4 a[24:27], v5, s[8:11], s25 offen offset:2048 sc1
    buffer_load_dwordx4 a[28:31], v5, s[8:11], s25 offen offset:3072 sc1
    ds_read_b128 v[16:19], v7 offset:0
    ds_read_b128 v[20:23], v7 offset:1024
    ds_read_b128 v[24:27], v7 offset:2048
    ds_read_b128 v[28:31], v7 offset:3072
    ds_read_b128 v[32:35], v7 offset:4096
    s_waitcnt vmcnt(6)
    ds_read_b128 v[36:39], v7 offset:5120
    s_waitcnt lgkmcnt(5)
    v_mfma_f32_32x32x16_bf16 v[40:55], v[16:19], a[0:3], 0
    s_add_u32 s25, s20, 8192
    buffer_load_dwordx4 a[32:35], v5, s[8:11], s25 offen offset:0 sc1
    ds_read_b128 v[16:19], v7 offset:6144
    s_waitcnt lgkmcnt(5)
    v_mfma_f32_32x32x16_bf16 v[40:55], v[20:23], a[4:7], v[40:55]
    buffer_load_dwordx4 a[36:39], v5, s[8:11], s25 offen offset:1024 sc1
    ds_read_b128 v[20:23], v7 offset:7168
    s_waitcnt lgkmcnt(5)
    v_mfma_f32_32x32x16_bf16 v[40:55], v[24:27], a[8:11], v[40:55]
    buffer_load_dwordx4 a[40:43], v5, s[8:11], s25 offen offset:2048 sc1
    ds_read_b128 v[24:27], v7 offset:8192
    s_waitcnt lgkmcnt(5)
    v_mfma_f32_32x32x16_bf16 v[40:55], v[28:31], a[12:15], v[40:55]
    buffer_load_dwordx4 a[44:47], v5, s[8:11], s25 offen offset:3072 sc1
    s_waitcnt vmcnt(4)
    ds_read_b128 v[28:31], v7 offset:9216
    s_waitcnt lgkmcnt(5)
    v_mfma_f32_32x32x16_bf16 v[40:55], v[32:35], a[16:19], v[40:55]
    s_add_u32 s25, s20, 12288
    buffer_load_dwordx4 a[48:51], v5, s[8:11], s25 offen offset:0 sc1
    ds_read_b128 v[32:35], v7 offset:10240
    s_waitcnt lgkmcnt(5)
    v_mfma_f32_32x32x16_bf16 v[40:55], v[36:39], a[20:23], v[40:55]
    buffer_load_dwordx4 a[52:55], v5, s[8:11], s25 offen offset:1024 sc1
    ds_read_b128 v[36:39], v7 offset:11264
    s_waitcnt lgkmcnt(5)
    v_mfma_f32_32x32x16_bf16 v[40:55], v[16:19], a[24:27], v[40:55]
    buffer_load_dwordx4 a[56:59], v5, s[8:11], s25 offen offset:2048 sc1
    ds_read_b128 v[16:19], v7 offset:12288
    s_waitcnt lgkmcnt(5)
    v_mfma_f32_32x32x16_bf16 v[40:55], v[20:23], a[28:31], v[40:55]
    buffer_load_dwordx4 a[60:63], v5, s[8:11], s25 offen offset:3072 sc1
    s_waitcnt vmcnt(4)
    ds_read_b128 v[20:23], v7 offset:13312
    s_waitcnt lgkmcnt(5)
    v_mfma_f32_32x32x16_bf16 v[40:55], v[24:27], a[32:35], v[40:55]
    s_add_u32 s25, s20, 16384
    buffer_load_dwordx4 a[64:67], v5, s[8:11], s25 offen offset:0 sc1
    ds_read_b128 v[24:27], v7 offset:14336
    s_waitcnt lgkmcnt(5)
    v_mfma_f32_32x32x16_bf16 v[40:55], v[28:31], a[36:39], v[40:55]
    buffer_load_dwordx4 a[68:71], v5, s[8:11], s25 offen offset:1024 sc1
    ds_read_b128 v[28:31], v7 offset:15360
    s_waitcnt lgkmcnt(5)
    v_mfma_f32_32x32x16_bf16 v[40:55], v[32:35], a[40:43], v[40:55]
    buffer_load_dwordx4 a[72:75], v5, s[8:11], s25 offen offset:2048 sc1
    ds_read_b128 v[32:35], v7 offset:16384
    s_waitcnt lgkmcnt(5)
    v_mfma_f32_32x32x16_bf16 v[40:55], v[36:39], a[44:47], v[40:55]
    buffer_load_dwordx4 a[76:79], v5, s[8:11], s25 offen offset:3072 sc1
    s_waitcnt vmcnt(4)
    ds_read_b128 v[36:39], v7 offset:17408
    s_waitcnt lgkmcnt(5)
    v_mfma_f32_32x32x16_bf16 v[40:55], v[16:19], a[48:51], v[40:55]
    s_add_u32 s25, s20, 20480
    buffer_load_dwordx4 a[80:83], v5, s[8:11], s25 offen offset:0 sc1
    ds_read_b128 v[16:19], v7 offset:18432
    s_waitcnt lgkmcnt(5)
    v_mfma_f32_32x32x16_bf16 v[40:55], v[20:23], a[52:55], v[40:55]
    buffer_load_dwordx4 a[84:87], v5, s[8:11], s25 offen offset:1024 sc1
    ds_read_b128 v[20:23], v7 offset:19456
    s_waitcnt lgkmcnt(5)
    v_mfma_f32_32x32x16_bf16 v[40:55], v[24:27], a[56:59], v[40:55]
    buffer_load_dwordx4 a[88:91], v5, s[8:11], s25 offen offset:2048 sc1
    ds_read_b128 v[24:27], v7 offset:20480
    s_waitcnt lgkmcnt(5)
    v_mfma_f32_32x32x16_bf16 v[40:55], v[28:31], a[60:63], v[40:55]
    buffer_load_dwordx4 a[92:95], v5, s[8:11], s25 offen offset:3072 sc1
    s_waitcnt vmcnt(4)
    ds_read_b128 v[28:31], v7 offset:21504
    s_waitcnt lgkmcnt(5)
    v_mfma_f32_32x32x16_bf16 v[40:55], v[32:35], a[64:67], v[40:55]
    s_add_u32 s25, s20, 24576
    buffer_load_dwordx4 a[96:99], v5, s[8:11], s25 offen offset:0 sc1
    ds_read_b128 v[32:35], v7 offset:22528
    s_waitcnt lgkmcnt(5)
    v_mfma_f32_32x32x16_bf16 v[40:55], v[36:39], a[68:71], v[40:55]
    buffer_load_dwordx4 a[100:103], v5, s[8:11], s25 offen offset:1024 sc1
    ds_read_b128 v[36:39], v7 offset:23552
    s_waitcnt lgkmcnt(5)
    v_mfma_f32_32x32x16_bf16 v[40:55], v[16:19], a[72:75], v[40:55]
    buffer_load_dwordx4 a[104:107], v5, s[8:11], s25 offen offset:2048 sc1
    ds_read_b128 v[16:19], v7 offset:24576
    s_waitcnt lgkmcnt(5)
    v_mfma_f32_32x32x16_bf16 v[40:55], v[20:23], a[76:79], v[40:55]
    buffer_load_dwordx4 a[108:111], v5, s[8:11], s25 offen offset:3072 sc1
    s_waitcnt vmcnt(4)
    ds_read_b128 v[20:23], v7 offset:25600
    s_waitcnt lgkmcnt(5)
    v_mfma_f32_32x32x16_bf16 v[40:55], v[24:27], a[80:83], v[40:55]
    s_add_u32 s25, s20, 28672
    buffer_load_dwordx4 a[112:115], v5, s[8:11], s25 offen offset:0 sc1
    ds_read_b128 v[24:27], v7 offset:26624
    s_waitcnt lgkmcnt(5)
    v_mfma_f32_32x32x16_bf16 v[40:55], v[28:31], a[84:87], v[40:55]
    buffer_load_dwordx4 a[116:119], v5, s[8:11], s25 offen offset:1024 sc1
    ds_read_b128 v[28:31], v7 offset:27648
    s_waitcnt lgkmcnt(5)
    v_mfma_f32_32x32x16_bf16 v[40:55], v[32:35], a[88:91], v[40:55]
    buffer_load_dwordx4 a[120:123], v5, s[8:11], s25 offen offset:2048 sc1
    ds_read_b128 v[32:35], v7 offset:28672
    s_waitcnt lgkmcnt(5)
    v_mfma_f32_32x32x16_bf16 v[40:55], v[36:39], a[92:95], v[40:55]
    buffer_load_dwordx4 a[124:127], v5, s[8:11], s25 offen offset:3072 sc1
    s_waitcnt vmcnt(4)
    ds_read_b128 v[36:39], v7 offset:29696
    s_waitcnt lgkmcnt(5)
    v_mfma_f32_32x32x16_bf16 v[40:55], v[16:19], a[96:99], v[40:55]
    ds_read_b128 v[16:19], v7 offset:30720
    s_waitcnt lgkmcnt(5)
    v_mfma_f32_32x32x16_bf16 v[40:55], v[20:23], a[100:103], v[40:55]
    ds_read_b128 v[20:23], v7 offset:31744
    s_waitcnt lgkmcnt(5)
    v_mfma_f32_32x32x16_bf16 v[40:55], v[24:27], a[104:107], v[40:55]
    s_waitcnt lgkmcnt(4)
    v_mfma_f32_32x32x16_bf16 v[40:55], v[28:31], a[108:111], v[40:55]
    s_waitcnt vmcnt(0)
    s_waitcnt lgkmcnt(3)
    v_mfma_f32_32x32x16_bf16 v[40:55], v[32:35], a[112:115], v[40:55]
    s_waitcnt lgkmcnt(2)
    v_mfma_f32_32x32x16_bf16 v[40:55], v[36:39], a[116:119], v[40:55]
    s_waitcnt lgkmcnt(1)
    v_mfma_f32_32x32x16_bf16 v[40:55], v[16:19], a[120:123], v[40:55]
    s_waitcnt lgkmcnt(0)
    v_mfma_f32_32x32x16_bf16 v[40:55], v[20:23], a[124:127], v[40:55]
    v_lshlrev_b32 v10, 16, v88
    v_and_b32 v11, 0xffff0000, v88
    s_nop 9
    v_add_f32 v40, v40, v10
    v_add_f32 v41, v41, v11
    v_cvt_pk_bf16_f32 v88, v40, v41
    v_lshlrev_b32 v10, 16, v89
    v_and_b32 v11, 0xffff0000, v89
    v_add_f32 v42, v42, v10
    v_add_f32 v43, v43, v11
    v_cvt_pk_bf16_f32 v89, v42, v43
    v_lshlrev_b32 v10, 16, v90
    v_and_b32 v11, 0xffff0000, v90
    v_add_f32 v44, v44, v10
    v_add_f32 v45, v45, v11
    v_cvt_pk_bf16_f32 v90, v44, v45
    v_lshlrev_b32 v10, 16, v91
    v_and_b32 v11, 0xffff0000, v91
    v_add_f32 v46, v46, v10
    v_add_f32 v47, v47, v11
    v_cvt_pk_bf16_f32 v91, v46, v47
    v_lshlrev_b32 v10, 16, v92
    v_and_b32 v11, 0xffff0000, v92
    v_add_f32 v48, v48, v10
    v_add_f32 v49, v49, v11
    v_cvt_pk_bf16_f32 v92, v48, v49
    v_lshlrev_b32 v10, 16, v93
    v_and_b32 v11, 0xffff0000, v93
    v_add_f32 v50, v50, v10
    v_add_f32 v51, v51, v11
    v_cvt_pk_bf16_f32 v93, v50, v51
    v_lshlrev_b32 v10, 16, v94
    v_and_b32 v11, 0xffff0000, v94
    v_add_f32 v52, v52, v10
    v_add_f32 v53, v53, v11
    v_cvt_pk_bf16_f32 v94, v52, v53
    v_lshlrev_b32 v10, 16, v95
    v_and_b32 v11, 0xffff0000, v95
    v_add_f32 v54, v54, v10
    v_add_f32 v55, v55, v11
    v_cvt_pk_bf16_f32 v95, v54, v55
    s_add_u32 s30, s30, 0x0
    s_cmp_lg_u32 s68, 0
    s_cbranch_scc1 Lls_mega_10_loc
    buffer_store_dwordx4 v[88:91], v5, s[8:11], s30 offen sc1
    buffer_store_dwordx4 v[92:95], v5, s[8:11], s30 offen offset:1024 sc1
    s_branch Lls_mega_10_end
Lls_mega_10_loc:
    buffer_store_dwordx4 v[88:91], v5, s[8:11], s30 offen
    buffer_store_dwordx4 v[92:95], v5, s[8:11], s30 offen offset:1024
Lls_mega_10_end:
    v_mov_b32 v8, 0
    v_mov_b32 v9, 0
    v_lshlrev_b32 v10, 16, v88
    v_and_b32 v11, 0xffff0000, v88
    v_add_f32 v8, v8, v10
    v_fmac_f32 v9, v10, v10
    v_add_f32 v8, v8, v11
    v_fmac_f32 v9, v11, v11
    v_lshlrev_b32 v10, 16, v89
    v_and_b32 v11, 0xffff0000, v89
    v_add_f32 v8, v8, v10
    v_fmac_f32 v9, v10, v10
    v_add_f32 v8, v8, v11
    v_fmac_f32 v9, v11, v11
    v_lshlrev_b32 v10, 16, v90
    v_and_b32 v11, 0xffff0000, v90
    v_add_f32 v8, v8, v10
    v_fmac_f32 v9, v10, v10
    v_add_f32 v8, v8, v11
    v_fmac_f32 v9, v11, v11
    v_lshlrev_b32 v10, 16, v91
    v_and_b32 v11, 0xffff0000, v91
    v_add_f32 v8, v8, v10
    v_fmac_f32 v9, v10, v10
    v_add_f32 v8, v8, v11
    v_fmac_f32 v9, v11, v11
    v_lshlrev_b32 v10, 16, v92
    v_and_b32 v11, 0xffff0000, v92
    v_add_f32 v8, v8, v10
    v_fmac_f32 v9, v10, v10
    v_add_f32 v8, v8, v11
    v_fmac_f32 v9, v11, v11
    v_lshlrev_b32 v10, 16, v93
    v_and_b32 v11, 0xffff0000, v93
    v_add_f32 v8, v8, v10
    v_fmac_f32 v9, v10, v10
    v_add_f32 v8, v8, v11
    v_fmac_f32 v9, v11, v11
    v_lshlrev_b32 v10, 16, v94
    v_and_b32 v11, 0xffff0000, v94
    v_add_f32 v8, v8, v10
    v_fmac_f32 v9, v10, v10
    v_add_f32 v8, v8, v11
    v_fmac_f32 v9, v11, v11
    v_lshlrev_b32 v10, 16, v95
    v_and_b32 v11, 0xffff0000, v95
    v_add_f32 v8, v8, v10
    v_fmac_f32 v9, v10, v10
    v_add_f32 v8, v8, v11
    v_fmac_f32 v9, v11, v11
    v_mov_b32 v10, v8
    v_mov_b32 v11, v9
    s_nop 0
    v_permlane32_swap_b32 v8, v10
    v_permlane32_swap_b32 v9, v11
    v_add_f32 v8, v8, v10
    v_add_f32 v9, v9, v11
    v_lshlrev_b32 v10, 4, v3
    s_lshl_b32 s31, s15, 12
    s_add_u32 s31, s31, s60
    s_add_u32 s31, s31, 0x1c0000
    s_lshr_b32 s27, s17, 1
    s_lshl_b32 s27, s27, 9
    s_add_u32 s31, s31, s27
    s_and_b32 s27, s17, 1
    s_lshl_b32 s27, s27, 3
    s_add_u32 s31, s31, s27
    s_cmp_lg_u32 s68, 0
    s_cbranch_scc1 Lls_mega_11_loc
    buffer_store_dwordx2 v[8:9], v10, s[8:11], s31 offen sc1
    s_branch Lls_mega_11_end
Lls_mega_11_loc:
    buffer_store_dwordx2 v[8:9], v10, s[8:11], s31 offen
Lls_mega_11_end:
L_prjA_drain:
    s_waitcnt vmcnt(0)
L_prjA_sig:
    s_lshl_b32 s19, s16, 4
    s_add_u32 s19, s19, s17
    s_barrier
    s_cmp_lg_u32 s12, 0
    s_cbranch_scc1 LsprjA_mega_12
    s_lshl_b32 s58, s19, 7
    s_add_u32 s58, s58, s61
    s_add_u32 s58, s58, 131072
    v_mov_b32 v125, 0
    v_mov_b32 v126, s66
    v_mov_b32 v127, s67
    s_mov_b64 exec, 1
    s_cmp_lg_u32 s68, 0
    s_cbranch_scc1 Lls_mega_13_loc
    buffer_store_dwordx2 v[126:127], v125, s[8:11], s58 offen sc1
    s_branch Lls_mega_13_end
Lls_mega_13_loc:
    buffer_store_dwordx2 v[126:127], v125, s[8:11], s58 offen
Lls_mega_13_end:
    s_mov_b64 exec, -1
LsprjA_mega_12:
L_prjA_end:
    s_add_u32 s60, s60, 0x0
    s_and_b32 s16, s14, 1
    s_lshl_b32 s15, s13, 1
    s_add_u32 s16, s16, s15
    s_lshr_b32 s17, s14, 1
    s_and_b32 s15, s12, 3
    s_lshl_b32 s18, s16, 2
    s_add_u32 s15, s15, s18
    s_lshl_b32 s19, s16, 4
    s_cmp_lg_u32 s12, 0
    s_cbranch_scc1 Lwqb_mega_14_skip
    v_min_u32 v11, 13, v2
    v_lshlrev_b32 v11, 7, v11
    s_lshl_b32 s58, s19, 7
    s_add_u32 s58, s58, s61
    s_add_u32 s58, s58, 0x20000
    s_mov_b32 s59, 0
Lwqb_mega_14:
    buffer_load_dwordx2 v[12:13], v11, s[8:11], s58 offen sc1
    s_add_u32 s59, s59, 1
    s_waitcnt vmcnt(0)
    v_cmp_ne_u64 vcc, s[66:67], v[12:13]
    s_cmp_ge_u32 s59, 0x8000
    s_cbranch_scc1 Lwqb_mega_14_t
    s_nop 0
    s_cbranch_vccnz Lwqb_mega_14
Lwqb_mega_14_t:
Lwqb_mega_14_skip:
    s_waitcnt vmcnt(0)
    s_barrier
    s_cmp_ge_u32 s12, 4
    s_cbranch_scc1 L_qkvB_sig
    s_mul_i32 s20, s15, 28672
    s_add_u32 s20, s20, s60
    s_lshl_b32 s32, s15, 4
    s_add_u32 s32, s32, s17
    s_lshl_b32 s32, s32, 11
    s_add_u32 s32, s32, s60
    s_add_u32 s32, s32, 0x200000
    s_lshl_b32 s33, s17, 6
    s_add_u32 s33, s33, s15
    s_lshl_b32 s33, s33, 12
    s_add_u32 s33, s33, s60
    s_add_u32 s33, s33, 0x400000
    s_add_u32 s34, s33, 2048
    s_lshl_b32 s35, s12, 11
    s_add_u32 s35, s35, 106496
    v_add_u32 v121, s35, v5
    s_lshl_b32 s35, s12, 12
    s_add_u32 s35, s35, 114688
    v_add_u32 v122, s35, v5
    s_add_u32 s25, s20, 0
    buffer_load_dwordx4 a[0:3], v5, s[8:11], s25 offen offset:0 sc1
    buffer_load_dwordx4 a[4:7], v5, s[8:11], s25 offen offset:1024 sc1
    buffer_load_dwordx4 a[8:11], v5, s[8:11], s25 offen offset:2048 sc1
    buffer_load_dwordx4 a[12:15], v5, s[8:11], s25 offen offset:3072 sc1
    v_lshlrev_b32 v10, 4, v3
    v_lshl_add_u32 v10, v4, 11, v10
    s_lshl_b32 s27, s15, 12
    s_add_u32 s27, s27, s60
    s_add_u32 s27, s27, 0x1c0000
    buffer_load_dwordx4 v[40:43], v10, s[8:11], s27 offen offset:0 sc1
    buffer_load_dwordx4 v[44:47], v10, s[8:11], s27 offen offset:512 sc1
    buffer_load_dwordx4 v[48:51], v10, s[8:11], s27 offen offset:1024 sc1
    buffer_load_dwordx4 v[52:55], v10, s[8:11], s27 offen offset:1536 sc1
    v_lshlrev_b32 v11, 4, v4
    v_add_u32 v11, 45056, v11
    ds_read_b128 v[88:91], v11 offset:0
    ds_read_b128 v[92:95], v11 offset:32
    ds_read_b128 v[96:99], v11 offset:64
    ds_read_b128 v[100:103], v11 offset:96
    v_lshlrev_b32 v11, 4, v4
    v_add_u32 v11, 74752, v11
    ds_read_b128 v[104:107], v11 offset:0
    ds_read_b128 v[108:111], v11 offset:32
    ds_read_b128 v[112:115], v11 offset:64
    ds_read_b128 v[116:119], v11 offset:96
    v_lshlrev_b32 v11, 2, v3
    v_add_u32 v11, 104448, v11
    ds_read_b32 v120, v11
    s_add_u32 s25, s20, 4096
    buffer_load_dwordx4 a[16:19], v5, s[8:11], s25 offen offset:0 sc1
    buffer_load_dwordx4 a[20:23], v5, s[8:11], s25 offen offset:1024 sc1
    buffer_load_dwordx4 a[24:27], v5, s[8:11], s25 offen offset:2048 sc1
    buffer_load_dwordx4 a[28:31], v5, s[8:11], s25 offen offset:3072 sc1
    ds_read_b128 v[16:19], v5 offset:46080
    ds_read_b128 v[20:23], v6 offset:10240
    ds_read_b128 v[24:27], v5 offset:47104
    ds_read_b128 v[28:31], v6 offset:11264
    ds_read_b128 v[32:35], v5 offset:48128
    s_waitcnt vmcnt(8)
    ds_read_b128 v[36:39], v6 offset:12288
    s_waitcnt lgkmcnt(5)
    v_mfma_f32_32x32x16_bf16 v[56:71], v[16:19], a[0:3], 0
    s_add_u32 s25, s20, 8192
    buffer_load_dwordx4 a[32:35], v5, s[8:11], s25 offen offset:0 sc1
    ds_read_b128 v[16:19], v5 offset:49152
    s_waitcnt lgkmcnt(5)
    v_mfma_f32_32x32x16_bf16 v[72:87], a[0:3], v[20:23], 0
    ds_read_b128 v[20:23], v6 offset:13312
    s_waitcnt lgkmcnt(5)
    v_mfma_f32_32x32x16_bf16 v[56:71], v[24:27], a[4:7], v[56:71]
    buffer_load_dwordx4 a[36:39], v5, s[8:11], s25 offen offset:1024 sc1
    ds_read_b128 v[24:27], v5 offset:50176
    s_waitcnt lgkmcnt(5)
    v_mfma_f32_32x32x16_bf16 v[72:87], a[4:7], v[28:31], v[72:87]
    ds_read_b128 v[28:31], v6 offset:14336
    s_waitcnt lgkmcnt(5)
    v_mfma_f32_32x32x16_bf16 v[56:71], v[32:35], a[8:11], v[56:71]
    buffer_load_dwordx4 a[40:43], v5, s[8:11], s25 offen offset:2048 sc1
    ds_read_b128 v[32:35], v5 offset:51200
    s_waitcnt lgkmcnt(5)
    v_mfma_f32_32x32x16_bf16 v[72:87], a[8:11], v[36:39], v[72:87]
    ds_read_b128 v[36:39], v6 offset:15360
    s_waitcnt lgkmcnt(5)
    v_mfma_f32_32x32x16_bf16 v[56:71], v[16:19], a[12:15], v[56:71]
    buffer_load_dwordx4 a[44:47], v5, s[8:11], s25 offen offset:3072 sc1
    ds_read_b128 v[16:19], v5 offset:52224
    s_waitcnt lgkmcnt(5)
    v_mfma_f32_32x32x16_bf16 v[72:87], a[12:15], v[20:23], v[72:87]
    s_waitcnt vmcnt(4)
    ds_read_b128 v[20:23], v6 offset:16384
    s_waitcnt lgkmcnt(5)
    v_mfma_f32_32x32x16_bf16 v[56:71], v[24:27], a[16:19], v[56:71]
    s_add_u32 s25, s20, 12288
    buffer_load_dwordx4 a[48:51], v5, s[8:11], s25 offen offset:0 sc1
    v_cmp_eq_u32 vcc, 0, v4
    s_nop 1
    v_cndmask_b32 v12, 0, -1, vcc
    v_and_b32 v52, v52, v12
    v_and_b32 v53, v53, v12
    v_and_b32 v54, v54, v12
    v_and_b32 v55, v55, v12
    v_add_f32 v40, v40, v42
    v_add_f32 v41, v41, v43
    v_add_f32 v40, v40, v44
    v_add_f32 v41, v41, v45
    v_add_f32 v40, v40, v46
    v_add_f32 v41, v41, v47
    v_add_f32 v40, v40, v48
    v_add_f32 v41, v41, v49
    v_add_f32 v40, v40, v50
    v_add_f32 v41, v41, v51
    v_add_f32 v40, v40, v52
    v_add_f32 v41, v41, v53
    v_add_f32 v40, v40, v54
    v_add_f32 v41, v41, v55
    v_mov_b32 v42, v40
    v_mov_b32 v43, v41
    s_nop 0
    v_permlane32_swap_b32 v40, v42
    v_permlane32_swap_b32 v41, v43
    v_add_f32 v40, v40, v42
    v_add_f32 v41, v41, v43
    v_mul_f32 v8, 0xbb124925, v40
    v_mul_f32 v10, 0x3b124925, v41
    v_fma_f32 v10, -v8, v8, v10
    v_max_f32 v10, 0, v10
    v_add_f32 v10, 0x3727c5ac, v10
    v_rsq_f32 v9, v10
    s_nop 0
    v_mul_f32 v14, 0x3e8b97f6, v9
    s_lshl_b32 s28, s12, 8
    v_lshl_add_u32 v10, v3, 3, s28
    ds_write_b64 v10, v[8:9]
    v_lshl_add_u32 v123, v4, 5, s28
    v_cmp_gt_u32 vcc, 28, v3
    s_nop 1
    v_cndmask_b32 v124, 0, -1, vcc
    v_mov_b32 v11, 0x3f803f80
    v_cmp_eq_u32 vcc, 28, v3
    s_nop 1
    v_cndmask_b32 v13, 0, v11, vcc
    ds_read_b128 v[24:27], v5 offset:53248
    s_waitcnt lgkmcnt(5)
    v_mfma_f32_32x32x16_bf16 v[72:87], a[16:19], v[28:31], v[72:87]
    ds_read_b128 v[28:31], v6 offset:17408
    s_waitcnt lgkmcnt(5)
    v_mfma_f32_32x32x16_bf16 v[56:71], v[32:35], a[20:23], v[56:71]
    buffer_load_dwordx4 a[52:55], v5, s[8:11], s25 offen offset:1024 sc1
    ds_read_b128 v[32:35], v5 offset:54272
    s_waitcnt lgkmcnt(5)
    v_mfma_f32_32x32x16_bf16 v[72:87], a[20:23], v[36:39], v[72:87]
    ds_read_b128 v[36:39], v6 offset:18432
    s_waitcnt lgkmcnt(5)
    v_mfma_f32_32x32x16_bf16 v[56:71], v[16:19], a[24:27], v[56:71]
    buffer_load_dwordx4 a[56:59], v5, s[8:11], s25 offen offset:2048 sc1
    ds_read_b128 v[16:19], v5 offset:55296
    s_waitcnt lgkmcnt(5)
    v_mfma_f32_32x32x16_bf16 v[72:87], a[24:27], v[20:23], v[72:87]
    ds_read_b128 v[20:23], v6 offset:19456
    s_waitcnt lgkmcnt(5)
    v_mfma_f32_32x32x16_bf16 v[56:71], v[24:27], a[28:31], v[56:71]
    buffer_load_dwordx4 a[60:63], v5, s[8:11], s25 offen offset:3072 sc1
    ds_read_b128 v[24:27], v5 offset:56320
    s_waitcnt lgkmcnt(5)
    v_mfma_f32_32x32x16_bf16 v[72:87], a[28:31], v[28:31], v[72:87]
    s_waitcnt vmcnt(4)
    ds_read_b128 v[28:31], v6 offset:20480
    s_waitcnt lgkmcnt(5)
    v_mfma_f32_32x32x16_bf16 v[56:71], v[32:35], a[32:35], v[56:71]
    s_add_u32 s25, s20, 16384
    buffer_load_dwordx4 a[64:67], v5, s[8:11], s25 offen offset:0 sc1
    ds_read_b128 v[32:35], v5 offset:57344
    s_waitcnt lgkmcnt(5)
    v_mfma_f32_32x32x16_bf16 v[72:87], a[32:35], v[36:39], v[72:87]
    ds_read_b128 v[36:39], v6 offset:21504
    s_waitcnt lgkmcnt(5)
    v_mfma_f32_32x32x16_bf16 v[56:71], v[16:19], a[36:39], v[56:71]
    buffer_load_dwordx4 a[68:71], v5, s[8:11], s25 offen offset:1024 sc1
    ds_read_b128 v[16:19], v5 offset:58368
    s_waitcnt lgkmcnt(5)
    v_mfma_f32_32x32x16_bf16 v[72:87], a[36:39], v[20:23], v[72:87]
    ds_read_b128 v[20:23], v6 offset:22528
    s_waitcnt lgkmcnt(5)
    v_mfma_f32_32x32x16_bf16 v[56:71], v[24:27], a[40:43], v[56:71]
    buffer_load_dwordx4 a[72:75], v5, s[8:11], s25 offen offset:2048 sc1
    ds_read_b128 v[24:27], v5 offset:59392
    s_waitcnt lgkmcnt(5)
    v_mfma_f32_32x32x16_bf16 v[72:87], a[40:43], v[28:31], v[72:87]
    ds_read_b128 v[28:31], v6 offset:23552
    s_waitcnt lgkmcnt(5)
    v_mfma_f32_32x32x16_bf16 v[56:71], v[32:35], a[44:47], v[56:71]
    buffer_load_dwordx4 a[76:79], v5, s[8:11], s25 offen offset:3072 sc1
    ds_read_b128 v[32:35], v5 offset:60416
    s_waitcnt lgkmcnt(5)
    v_mfma_f32_32x32x16_bf16 v[72:87], a[44:47], v[36:39], v[72:87]
    s_waitcnt vmcnt(4)
    ds_read_b128 v[36:39], v6 offset:24576
    s_waitcnt lgkmcnt(5)
    v_mfma_f32_32x32x16_bf16 v[56:71], v[16:19], a[48:51], v[56:71]
    s_add_u32 s25, s20, 20480
    buffer_load_dwordx4 a[80:83], v5, s[8:11], s25 offen offset:0 sc1
    ds_read_b128 v[16:19], v5 offset:61440
    s_waitcnt lgkmcnt(5)
    v_mfma_f32_32x32x16_bf16 v[72:87], a[48:51], v[20:23], v[72:87]
    ds_read_b128 v[20:23], v6 offset:25600
    s_waitcnt lgkmcnt(5)
    v_mfma_f32_32x32x16_bf16 v[56:71], v[24:27], a[52:55], v[56:71]
    buffer_load_dwordx4 a[84:87], v5, s[8:11], s25 offen offset:1024 sc1
    ds_read_b128 v[24:27], v5 offset:62464
    s_waitcnt lgkmcnt(5)
    v_mfma_f32_32x32x16_bf16 v[72:87], a[52:55], v[28:31], v[72:87]
    ds_read_b128 v[28:31], v6 offset:26624
    s_waitcnt lgkmcnt(5)
    v_mfma_f32_32x32x16_bf16 v[56:71], v[32:35], a[56:59], v[56:71]
    buffer_load_dwordx4 a[88:91], v5, s[8:11], s25 offen offset:2048 sc1
    ds_read_b128 v[32:35], v5 offset:63488
    s_waitcnt lgkmcnt(5)
    v_mfma_f32_32x32x16_bf16 v[72:87], a[56:59], v[36:39], v[72:87]
    ds_read_b128 v[36:39], v6 offset:27648
    s_waitcnt lgkmcnt(5)
    v_mfma_f32_32x32x16_bf16 v[56:71], v[16:19], a[60:63], v[56:71]
    buffer_load_dwordx4 a[92:95], v5, s[8:11], s25 offen offset:3072 sc1
    ds_read_b128 v[16:19], v5 offset:64512
    s_waitcnt lgkmcnt(5)
    v_mfma_f32_32x32x16_bf16 v[72:87], a[60:63], v[20:23], v[72:87]
    s_waitcnt vmcnt(4)
    ds_read_b128 v[20:23], v6 offset:28672
    s_waitcnt lgkmcnt(5)
    v_mfma_f32_32x32x16_bf16 v[56:71], v[24:27], a[64:67], v[56:71]
    s_add_u32 s25, s20, 24576
    buffer_load_dwordx4 a[96:99], v5, s[8:11], s25 offen offset:0 sc1
    ds_read_b128 v[24:27], v6 offset:0
    s_waitcnt lgkmcnt(5)
    v_mfma_f32_32x32x16_bf16 v[72:87], a[64:67], v[28:31], v[72:87]
    ds_read_b128 v[28:31], v6 offset:29696
    s_waitcnt lgkmcnt(5)
    v_mfma_f32_32x32x16_bf16 v[56:71], v[32:35], a[68:71], v[56:71]
    buffer_load_dwordx4 a[100:103], v5, s[8:11], s25 offen offset:1024 sc1
    ds_read_b128 v[32:35], v6 offset:1024
    s_waitcnt lgkmcnt(5)
    v_mfma_f32_32x32x16_bf16 v[72:87], a[68:71], v[36:39], v[72:87]
    ds_read_b128 v[36:39], v6 offset:30720
    s_waitcnt lgkmcnt(5)
    v_mfma_f32_32x32x16_bf16 v[56:71], v[16:19], a[72:75], v[56:71]
    buffer_load_dwordx4 a[104:107], v5, s[8:11], s25 offen offset:2048 sc1
    ds_read_b128 v[16:19], v6 offset:2048
    s_waitcnt lgkmcnt(5)
    v_mfma_f32_32x32x16_bf16 v[72:87], a[72:75], v[20:23], v[72:87]
    ds_read_b128 v[20:23], v6 offset:31744
    s_waitcnt lgkmcnt(5)
    v_mfma_f32_32x32x16_bf16 v[56:71], v[24:27], a[76:79], v[56:71]
    buffer_load_dwordx4 a[108:111], v5, s[8:11], s25 offen offset:3072 sc1
    ds_read_b128 v[24:27], v6 offset:3072
    s_waitcnt lgkmcnt(5)
    v_mfma_f32_32x32x16_bf16 v[72:87], a[76:79], v[28:31], v[72:87]
    s_waitcnt vmcnt(4)
    ds_read_b128 v[28:31], v6 offset:32768
    s_waitcnt lgkmcnt(5)
    v_mfma_f32_32x32x16_bf16 v[56:71], v[32:35], a[80:83], v[56:71]
    ds_read_b128 v[32:35], v6 offset:4096
    s_waitcnt lgkmcnt(5)
    v_mfma_f32_32x32x16_bf16 v[72:87], a[80:83], v[36:39], v[72:87]
    ds_read_b128 v[36:39], v6 offset:33792
    s_waitcnt lgkmcnt(5)
    v_mfma_f32_32x32x16_bf16 v[56:71], v[16:19], a[84:87], v[56:71]
    ds_read_b128 v[16:19], v6 offset:5120
    s_waitcnt lgkmcnt(5)
    v_mfma_f32_32x32x16_bf16 v[72:87], a[84:87], v[20:23], v[72:87]
    ds_read_b128 v[20:23], v6 offset:34816
    s_waitcnt lgkmcnt(5)
    v_mfma_f32_32x32x16_bf16 v[56:71], v[24:27], a[88:91], v[56:71]
    ds_read_b128 v[24:27], v6 offset:6144
    s_waitcnt lgkmcnt(5)
    v_mfma_f32_32x32x16_bf16 v[72:87], a[88:91], v[28:31], v[72:87]
    ds_read_b128 v[28:31], v6 offset:35840
    s_waitcnt lgkmcnt(5)
    v_mfma_f32_32x32x16_bf16 v[56:71], v[32:35], a[92:95], v[56:71]
    ds_read_b128 v[32:35], v6 offset:7168
    s_waitcnt lgkmcnt(5)
    v_mfma_f32_32x32x16_bf16 v[72:87], a[92:95], v[36:39], v[72:87]
    s_waitcnt vmcnt(0)
    ds_read_b128 v[36:39], v6 offset:36864
    s_waitcnt lgkmcnt(5)
    v_mfma_f32_32x32x16_bf16 v[56:71], v[16:19], a[96:99], v[56:71]
    ds_read_b128 v[16:19], v6 offset:8192
    s_waitcnt lgkmcnt(5)
    v_mfma_f32_32x32x16_bf16 v[72:87], a[96:99], v[20:23], v[72:87]
    ds_read_b128 v[20:23], v6 offset:37888
    s_waitcnt lgkmcnt(5)
    v_mfma_f32_32x32x16_bf16 v[56:71], v[24:27], a[100:103], v[56:71]
    ds_read_b128 v[24:27], v5 offset:16384
    s_waitcnt lgkmcnt(5)
    v_mfma_f32_32x32x16_bf16 v[72:87], a[100:103], v[28:31], v[72:87]
    ds_read_b128 v[28:31], v5 offset:17408
    s_waitcnt lgkmcnt(5)
    v_mfma_f32_32x32x16_bf16 v[56:71], v[32:35], a[104:107], v[56:71]
    ds_read_b128 v[32:35], v5 offset:18432
    s_waitcnt lgkmcnt(5)
    v_mfma_f32_32x32x16_bf16 v[72:87], a[104:107], v[36:39], v[72:87]
    ds_read_b128 v[36:39], v5 offset:19456
    s_waitcnt lgkmcnt(5)
    v_mfma_f32_32x32x16_bf16 v[56:71], v[16:19], a[108:111], v[56:71]
    ds_read_b128 v[16:19], v5 offset:20480
    s_waitcnt lgkmcnt(5)
    v_mfma_f32_32x32x16_bf16 v[72:87], a[108:111], v[20:23], v[72:87]
    ds_read_b128 v[20:23], v5 offset:21504
    s_waitcnt lgkmcnt(5)
    v_mfma_f32_32x32x16_bf16 v[40:55], v[24:27], a[0:3], 0
    ds_read_b128 v[24:27], v5 offset:22528
    s_waitcnt lgkmcnt(5)
    v_mfma_f32_32x32x16_bf16 v[40:55], v[28:31], a[4:7], v[40:55]
    ds_read_b128 v[28:31], v5 offset:23552
    s_waitcnt lgkmcnt(5)
    v_mfma_f32_32x32x16_bf16 v[40:55], v[32:35], a[8:11], v[40:55]
    v_fmac_f32 v56, v104, v8
    v_mul_f32 v56, v56, v9
    v_fmac_f32 v57, v105, v8
    v_mul_f32 v57, v57, v9
    v_fmac_f32 v58, v106, v8
    v_mul_f32 v58, v58, v9
    ds_read_b128 v[32:35], v5 offset:24576
    s_waitcnt lgkmcnt(5)
    v_mfma_f32_32x32x16_bf16 v[40:55], v[36:39], a[12:15], v[40:55]
    v_fmac_f32 v59, v107, v8
    v_mul_f32 v59, v59, v9
    v_fmac_f32 v60, v108, v8
    v_mul_f32 v60, v60, v9
    v_fmac_f32 v61, v109, v8
    v_mul_f32 v61, v61, v9
    ds_read_b128 v[36:39], v5 offset:25600
    s_waitcnt lgkmcnt(5)
    v_mfma_f32_32x32x16_bf16 v[40:55], v[16:19], a[16:19], v[40:55]
    v_fmac_f32 v62, v110, v8
    v_mul_f32 v62, v62, v9
    v_fmac_f32 v63, v111, v8
    v_mul_f32 v63, v63, v9
    v_fmac_f32 v64, v112, v8
    v_mul_f32 v64, v64, v9
    ds_read_b128 v[16:19], v5 offset:26624
    s_waitcnt lgkmcnt(5)
    v_mfma_f32_32x32x16_bf16 v[40:55], v[20:23], a[20:23], v[40:55]
    v_fmac_f32 v65, v113, v8
    v_mul_f32 v65, v65, v9
    v_fmac_f32 v66, v114, v8
    v_mul_f32 v66, v66, v9
    v_fmac_f32 v67, v115, v8
    v_mul_f32 v67, v67, v9
    ds_read_b128 v[20:23], v5 offset:27648
    s_waitcnt lgkmcnt(5)
    v_mfma_f32_32x32x16_bf16 v[40:55], v[24:27], a[24:27], v[40:55]
    v_fmac_f32 v68, v116, v8
    v_mul_f32 v68, v68, v9
    v_fmac_f32 v69, v117, v8
    v_mul_f32 v69, v69, v9
    v_fmac_f32 v70, v118, v8
    v_mul_f32 v70, v70, v9
    ds_read_b128 v[24:27], v5 offset:28672
    s_waitcnt lgkmcnt(5)
    v_mfma_f32_32x32x16_bf16 v[40:55], v[28:31], a[28:31], v[40:55]
    v_fmac_f32 v71, v119, v8
    v_mul_f32 v71, v71, v9
    v_cvt_pk_bf16_f32 v56, v56, v57
    v_cvt_pk_bf16_f32 v57, v58, v59
    v_cvt_pk_bf16_f32 v58, v60, v61
    v_cvt_pk_bf16_f32 v59, v62, v63
    ds_read_b128 v[28:31], v5 offset:29696
    s_waitcnt lgkmcnt(5)
    v_mfma_f32_32x32x16_bf16 v[40:55], v[32:35], a[32:35], v[40:55]
    v_cvt_pk_bf16_f32 v60, v64, v65
    v_cvt_pk_bf16_f32 v61, v66, v67
    v_cvt_pk_bf16_f32 v62, v68, v69
    v_cvt_pk_bf16_f32 v63, v70, v71
    v_and_b32 v62, v62, v12
    v_and_b32 v63, v63, v12
    ds_read_b128 v[32:35], v5 offset:30720
    s_waitcnt lgkmcnt(5)
    v_mfma_f32_32x32x16_bf16 v[40:55], v[36:39], a[36:39], v[40:55]
    buffer_store_dwordx4 v[56:59], v5, s[8:11], s33 offen sc1
    buffer_store_dwordx4 v[60:63], v5, s[8:11], s33 offen offset:1024 sc1
    ds_write_b128 v122, v[56:59] offset:0
    ds_write_b128 v122, v[60:63] offset:1024
    ds_read_b128 v[104:107], v123 offset:0
    ds_read_b128 v[108:111], v123 offset:16
    ds_read_b128 v[36:39], v5 offset:31744
    s_waitcnt lgkmcnt(5)
    v_mfma_f32_32x32x16_bf16 v[40:55], v[16:19], a[40:43], v[40:55]
    ds_read_b128 v[112:115], v123 offset:64
    ds_read_b128 v[116:119], v123 offset:80
    s_waitcnt lgkmcnt(0)
    v_fmac_f32 v72, v120, v104
    v_mul_f32 v72, v72, v105
    v_fmac_f32 v73, v120, v106
    ds_read_b128 v[16:19], v5 offset:32768
    s_waitcnt lgkmcnt(5)
    v_mfma_f32_32x32x16_bf16 v[40:55], v[20:23], a[44:47], v[40:55]
    v_mul_f32 v73, v73, v107
    v_fmac_f32 v74, v120, v108
    v_mul_f32 v74, v74, v109
    v_fmac_f32 v75, v120, v110
    v_mul_f32 v75, v75, v111
    v_fmac_f32 v76, v120, v112
    ds_read_b128 v[20:23], v5 offset:33792
    s_waitcnt lgkmcnt(5)
    v_mfma_f32_32x32x16_bf16 v[40:55], v[24:27], a[48:51], v[40:55]
    v_mul_f32 v76, v76, v113
    v_fmac_f32 v77, v120, v114
    v_mul_f32 v77, v77, v115
    v_fmac_f32 v78, v120, v116
    v_mul_f32 v78, v78, v117
    v_fmac_f32 v79, v120, v118
    ds_read_b128 v[24:27], v5 offset:34816
    s_waitcnt lgkmcnt(5)
    v_mfma_f32_32x32x16_bf16 v[40:55], v[28:31], a[52:55], v[40:55]
    v_mul_f32 v79, v79, v119
    ds_read_b128 v[104:107], v123 offset:128
    ds_read_b128 v[108:111], v123 offset:144
    ds_read_b128 v[112:115], v123 offset:192
    ds_read_b128 v[116:119], v123 offset:208
    s_waitcnt lgkmcnt(0)
    ds_read_b128 v[28:31], v5 offset:35840
    s_waitcnt lgkmcnt(5)
    v_mfma_f32_32x32x16_bf16 v[40:55], v[32:35], a[56:59], v[40:55]
    v_fmac_f32 v80, v120, v104
    v_mul_f32 v80, v80, v105
    v_fmac_f32 v81, v120, v106
    v_mul_f32 v81, v81, v107
    v_fmac_f32 v82, v120, v108
    v_mul_f32 v82, v82, v109
    ds_read_b128 v[32:35], v5 offset:36864
    s_waitcnt lgkmcnt(5)
    v_mfma_f32_32x32x16_bf16 v[40:55], v[36:39], a[60:63], v[40:55]
    v_fmac_f32 v83, v120, v110
    v_mul_f32 v83, v83, v111
    v_fmac_f32 v84, v120, v112
    v_mul_f32 v84, v84, v113
    v_fmac_f32 v85, v120, v114
    v_mul_f32 v85, v85, v115
    ds_read_b128 v[36:39], v5 offset:37888
    s_waitcnt lgkmcnt(5)
    v_mfma_f32_32x32x16_bf16 v[40:55], v[16:19], a[64:67], v[40:55]
    v_fmac_f32 v86, v120, v116
    v_mul_f32 v86, v86, v117
    v_fmac_f32 v87, v120, v118
    v_mul_f32 v87, v87, v119
    v_cvt_pk_bf16_f32 v72, v72, v73
    v_and_or_b32 v72, v72, v124, v13
    ds_read_b128 v[16:19], v5 offset:38912
    s_waitcnt lgkmcnt(5)
    v_mfma_f32_32x32x16_bf16 v[40:55], v[20:23], a[68:71], v[40:55]
    v_cvt_pk_bf16_f32 v73, v74, v75
    v_and_or_b32 v73, v73, v124, v13
    v_cvt_pk_bf16_f32 v74, v76, v77
    v_and_or_b32 v74, v74, v124, v13
    v_cvt_pk_bf16_f32 v75, v78, v79
    v_and_or_b32 v75, v75, v124, v13
    ds_read_b128 v[20:23], v5 offset:39936
    s_waitcnt lgkmcnt(5)
    v_mfma_f32_32x32x16_bf16 v[40:55], v[24:27], a[72:75], v[40:55]
    v_cvt_pk_bf16_f32 v76, v80, v81
    v_and_or_b32 v76, v76, v124, v13
    v_cvt_pk_bf16_f32 v77, v82, v83
    v_and_or_b32 v77, v77, v124, v13
    v_cvt_pk_bf16_f32 v78, v84, v85
    v_and_or_b32 v78, v78, v124, v13
    ds_read_b128 v[24:27], v5 offset:40960
    s_waitcnt lgkmcnt(5)
    v_mfma_f32_32x32x16_bf16 v[40:55], v[28:31], a[76:79], v[40:55]
    v_cvt_pk_bf16_f32 v79, v86, v87
    v_and_or_b32 v79, v79, v124, v13
    buffer_store_dwordx4 v[72:75], v5, s[8:11], s34 offen sc1
    buffer_store_dwordx4 v[76:79], v5, s[8:11], s34 offen offset:1024 sc1
    ds_write_b128 v122, v[72:75] offset:2048
    ds_write_b128 v122, v[76:79] offset:3072
    ds_read_b128 v[28:31], v5 offset:41984
    s_waitcnt lgkmcnt(5)
    v_mfma_f32_32x32x16_bf16 v[40:55], v[32:35], a[80:83], v[40:55]
    ds_read_b128 v[32:35], v5 offset:43008
    s_waitcnt lgkmcnt(5)
    v_mfma_f32_32x32x16_bf16 v[40:55], v[36:39], a[84:87], v[40:55]
    ds_read_b128 v[36:39], v5 offset:44032
    s_waitcnt lgkmcnt(5)
    v_mfma_f32_32x32x16_bf16 v[40:55], v[16:19], a[88:91], v[40:55]
    s_waitcnt lgkmcnt(4)
    v_mfma_f32_32x32x16_bf16 v[40:55], v[20:23], a[92:95], v[40:55]
    s_waitcnt lgkmcnt(3)
    v_mfma_f32_32x32x16_bf16 v[40:55], v[24:27], a[96:99], v[40:55]
    s_waitcnt lgkmcnt(2)
    v_mfma_f32_32x32x16_bf16 v[40:55], v[28:31], a[100:103], v[40:55]
    s_waitcnt lgkmcnt(1)
    v_mfma_f32_32x32x16_bf16 v[40:55], v[32:35], a[104:107], v[40:55]
    s_waitcnt lgkmcnt(0)
    v_mfma_f32_32x32x16_bf16 v[40:55], v[36:39], a[108:111], v[40:55]
    s_nop 7
    s_waitcnt vmcnt(0)
L_qkvB_sig:
    s_lshl_b32 s19, s17, 4
    s_add_u32 s19, s19, s16
    s_barrier
    s_cmp_lg_u32 s12, 0
    s_cbranch_scc1 Lsqb_mega_15
    s_lshl_b32 s58, s19, 7
    s_add_u32 s58, s58, s61
    s_add_u32 s58, s58, 196608
    v_mov_b32 v125, 0
    v_mov_b32 v126, s66
    v_mov_b32 v127, s67
    s_mov_b64 exec, 1
    buffer_store_dwordx2 v[126:127], v125, s[8:11], s58 offen sc1
    s_mov_b64 exec, -1
Lsqb_mega_15:
    s_cmp_ge_u32 s12, 4
    s_cbranch_scc1 L_qkvB_end
    v_fmac_f32 v40, v88, v8
    v_mul_f32 v40, v40, v14
    v_fmac_f32 v41, v89, v8
    v_mul_f32 v41, v41, v14
    v_fmac_f32 v42, v90, v8
    v_mul_f32 v42, v42, v14
    v_fmac_f32 v43, v91, v8
    v_mul_f32 v43, v43, v14
    v_fmac_f32 v44, v92, v8
    v_mul_f32 v44, v44, v14
    v_fmac_f32 v45, v93, v8
    v_mul_f32 v45, v45, v14
    v_fmac_f32 v46, v94, v8
    v_mul_f32 v46, v46, v14
    v_fmac_f32 v47, v95, v8
    v_mul_f32 v47, v47, v14
    v_fmac_f32 v48, v96, v8
    v_mul_f32 v48, v48, v14
    v_fmac_f32 v49, v97, v8
    v_mul_f32 v49, v49, v14
    v_fmac_f32 v50, v98, v8
    v_mul_f32 v50, v50, v14
    v_fmac_f32 v51, v99, v8
    v_mul_f32 v51, v51, v14
    v_fmac_f32 v52, v100, v8
    v_mul_f32 v52, v52, v14
    v_fmac_f32 v53, v101, v8
    v_mul_f32 v53, v53, v14
    v_fmac_f32 v54, v102, v8
    v_mul_f32 v54, v54, v14
    v_fmac_f32 v55, v103, v8
    v_mul_f32 v55, v55, v14
    v_cvt_pk_bf16_f32 v40, v40, v41
    v_cvt_pk_bf16_f32 v41, v42, v43
    v_cvt_pk_bf16_f32 v42, v44, v45
    v_cvt_pk_bf16_f32 v43, v46, v47
    v_cvt_pk_bf16_f32 v44, v48, v49
    v_cvt_pk_bf16_f32 v45, v50, v51
    v_cvt_pk_bf16_f32 v46, v52, v53
    v_cvt_pk_bf16_f32 v47, v54, v55
    v_and_b32 v46, v46, v12
    v_and_b32 v47, v47, v12
    ds_write_b128 v121, v[40:43] offset:0
    ds_write_b128 v121, v[44:47] offset:1024
    s_waitcnt lgkmcnt(0)
L_qkvB_end:
    s_barrier
    s_and_b32 s20, s14, 1
    s_lshr_b32 s21, s14, 1
    s_lshl_b32 s22, s13, 1
    s_add_u32 s20, s20, s22
    s_and_b32 s33, s12, 3
    s_lshr_b32 s34, s12, 2
    s_lshl_b32 s15, s20, 2
    s_add_u32 s15, s15, s33
    s_lshl_b32 s17, s15, 4
    s_add_u32 s17, s17, s21
    s_lshl_b32 s17, s17, 11
    s_add_u32 s17, s17, s60
    s_add_u32 s17, s17, 0x800000
    s_lshl_b32 s24, s33, 12
    s_add_u32 s24, s24, 114688
    v_add_u32 v124, s24, v5
    s_lshl_b32 s24, s33, 11
    s_add_u32 s24, s24, 106496
    v_add_u32 v122, s24, v5
    ds_read_b128 v[8:11], v122
    ds_read_b128 v[12:15], v122 offset:1024
    ds_read_b128 v[16:19], v124
    ds_read_b128 v[20:23], v124 offset:1024
    ds_read_b128 v[24:27], v124 offset:2048
    ds_read_b128 v[28:31], v124 offset:3072
    s_sub_u32 s35, 9, s33
    s_lshr_b32 s35, s35, 1
    s_sub_u32 s35, s35, 1
    s_sub_u32 s36, 7, s33
    s_sub_u32 s36, s36, s35
    s_cmp_eq_u32 s34, 0
    s_cbranch_scc1 L_attnB_masks
    s_cmp_ge_u32 s20, 2
    s_cbranch_scc1 L_attnB_nozero
    v_mov_b32 v48, 0
    v_mov_b32 v49, 0
    v_mov_b32 v50, 0
    v_mov_b32 v51, 0
    s_lshl_b32 s24, s33, 12
    v_add_u32 v122, s24, v5
    ds_write_b128 v122, v[48:51] offset:0
    ds_write_b128 v122, v[48:51] offset:1024
    ds_write_b128 v122, v[48:51] offset:2048
    ds_write_b128 v122, v[48:51] offset:3072
    s_cmp_ge_u32 s20, 1
    s_cbranch_scc1 L_attnB_nozero
    ds_write_b128 v122, v[48:51] offset:16384
    ds_write_b128 v122, v[48:51] offset:17408
    ds_write_b128 v122, v[48:51] offset:18432
    ds_write_b128 v122, v[48:51] offset:19456
    s_branch L_attnB_nodma
L_attnB_nozero:
    v_and_b32 v121, 1, v2
    v_add_u32 v121, 1, v121
    v_sub_u32 v121, s20, v121
    v_max_i32 v121, 0, v121
    v_lshlrev_b32 v121, 7, v121
    s_lshl_b32 s58, s21, 11
    s_add_u32 s58, s58, s61
    s_add_u32 s58, s58, 196608
    s_lshl_b32 s18, s21, 6
    s_lshl_b32 s19, s20, 2
    s_add_u32 s18, s18, s19
    s_sub_u32 s18, s18, 8
    s_add_u32 s18, s18, s33
    s_lshl_b32 s18, s18, 12
    s_add_u32 s18, s18, s60
    s_add_u32 s18, s18, 0x400000
    s_mov_b32 s59, 0
L_attnB_poll:
    buffer_load_dwordx2 v[48:49], v121, s[8:11], s58 offen sc1
    s_add_u32 s59, s59, 1
    s_waitcnt vmcnt(0)
    v_cmp_ne_u64 vcc, s[66:67], v[48:49]
    s_cmp_ge_u32 s59, 0x8000
    s_cbranch_scc1 L_attnB_poll_t
    s_nop 0
    s_cbranch_vccnz L_attnB_poll
L_attnB_poll_t:
    s_lshl_b32 s24, s33, 12
    s_add_u32 m0, s24, 16384
    s_add_u32 s25, s18, 16384
    buffer_load_dwordx4 v5, s[8:11], s25 offen offset:0 sc1 lds
    buffer_load_dwordx4 v5, s[8:11], s25 offen offset:1024 sc1 lds
    buffer_load_dwordx4 v5, s[8:11], s25 offen offset:2048 sc1 lds
    buffer_load_dwordx4 v5, s[8:11], s25 offen offset:3072 sc1 lds
    s_cmp_lt_u32 s20, 2
    s_cbranch_scc1 L_attnB_nodma
    s_mov_b32 m0, s24
    s_nop 0
    buffer_load_dwordx4 v5, s[8:11], s18 offen offset:0 sc1 lds
    buffer_load_dwordx4 v5, s[8:11], s18 offen offset:1024 sc1 lds
    buffer_load_dwordx4 v5, s[8:11], s18 offen offset:2048 sc1 lds
    buffer_load_dwordx4 v5, s[8:11], s18 offen offset:3072 sc1 lds
L_attnB_nodma:
L_attnB_masks:
    v_lshlrev_b32 v120, 2, v4
    v_sub_u32 v120, v3, v120
    v_mov_b32 v121, 0xf149f2ca
    v_cmp_le_i32 vcc, 0, v120
    s_nop 1
    v_cndmask_b32 v104, v121, 0, vcc
    v_cmp_le_i32 vcc, 1, v120
    s_nop 1
    v_cndmask_b32 v105, v121, 0, vcc
    v_cmp_le_i32 vcc, 2, v120
    s_nop 1
    v_cndmask_b32 v106, v121, 0, vcc
    v_cmp_le_i32 vcc, 3, v120
    s_nop 1
    v_cndmask_b32 v107, v121, 0, vcc
    v_cmp_le_i32 vcc, 8, v120
    s_nop 1
    v_cndmask_b32 v108, v121, 0, vcc
    v_cmp_le_i32 vcc, 9, v120
    s_nop 1
    v_cndmask_b32 v109, v121, 0, vcc
    v_cmp_le_i32 vcc, 10, v120
    s_nop 1
    v_cndmask_b32 v110, v121, 0, vcc
    v_cmp_le_i32 vcc, 11, v120
    s_nop 1
    v_cndmask_b32 v111, v121, 0, vcc
    v_cmp_le_i32 vcc, 16, v120
    s_nop 1
    v_cndmask_b32 v112, v121, 0, vcc
    v_cmp_le_i32 vcc, 17, v120
    s_nop 1
    v_cndmask_b32 v113, v121, 0, vcc
    v_cmp_le_i32 vcc, 18, v120
    s_nop 1
    v_cndmask_b32 v114, v121, 0, vcc
    v_cmp_le_i32 vcc, 19, v120
    s_nop 1
    v_cndmask_b32 v115, v121, 0, vcc
    v_cmp_le_i32 vcc, 24, v120
    s_nop 1
    v_cndmask_b32 v116, v121, 0, vcc
    v_cmp_le_i32 vcc, 25, v120
    s_nop 1
    v_cndmask_b32 v117, v121, 0, vcc
    v_cmp_le_i32 vcc, 26, v120
    s_nop 1
    v_cndmask_b32 v118, v121, 0, vcc
    v_cmp_le_i32 vcc, 27, v120
    s_nop 1
    v_cndmask_b32 v119, v121, 0, vcc
    s_waitcnt lgkmcnt(0)
    s_nop 0
    v_mfma_f32_32x32x16_bf16 v[48:63], v[16:19], v[8:11], v[104:119]
    v_mfma_f32_32x32x16_bf16 v[48:63], v[20:23], v[12:15], v[48:63]
    v_subrev_u32 v125, 0x1000, v124
    s_nop 10
    v_max3_f32 v120, v48, v49, v50
    v_max3_f32 v120, v120, v51, v52
    v_max3_f32 v120, v120, v53, v54
    v_max3_f32 v120, v120, v55, v56
    v_max3_f32 v120, v120, v57, v58
    v_max3_f32 v120, v120, v59, v60
    v_max3_f32 v120, v120, v61, v62
    v_max_f32 v120, v120, v63
    v_mov_b32 v121, v120
    s_nop 1
    v_permlane32_swap_b32 v120, v121
    v_max_f32 v120, v120, v121
    s_cmp_lg_u32 s34, 0
    s_cbranch_scc1 L_attnB_part1
    ds_read_b128 v[16:19], v125
    ds_read_b128 v[20:23], v125 offset:1024
    v_sub_f32 v104, 0, v120
    v_sub_f32 v48, v48, v120
    v_sub_f32 v105, 0, v120
    v_sub_f32 v49, v49, v120
    v_sub_f32 v106, 0, v120
    v_sub_f32 v50, v50, v120
    v_sub_f32 v107, 0, v120
    v_sub_f32 v51, v51, v120
    v_sub_f32 v108, 0, v120
    v_sub_f32 v52, v52, v120
    v_sub_f32 v109, 0, v120
    v_sub_f32 v53, v53, v120
    v_sub_f32 v110, 0, v120
    v_sub_f32 v54, v54, v120
    v_sub_f32 v111, 0, v120
    v_sub_f32 v55, v55, v120
    v_sub_f32 v112, 0, v120
    v_sub_f32 v56, v56, v120
    v_sub_f32 v113, 0, v120
    v_sub_f32 v57, v57, v120
    v_sub_f32 v114, 0, v120
    v_sub_f32 v58, v58, v120
    v_sub_f32 v115, 0, v120
    v_sub_f32 v59, v59, v120
    v_sub_f32 v116, 0, v120
    v_sub_f32 v60, v60, v120
    v_sub_f32 v117, 0, v120
    v_sub_f32 v61, v61, v120
    v_sub_f32 v118, 0, v120
    v_sub_f32 v62, v62, v120
    v_sub_f32 v119, 0, v120
    v_sub_f32 v63, v63, v120
    v_exp_f32 v48, v48
    v_exp_f32 v49, v49
    v_exp_f32 v50, v50
    v_exp_f32 v51, v51
    v_cvt_pk_bf16_f32 v80, v48, v49
    v_exp_f32 v52, v52
    v_exp_f32 v53, v53
    v_cvt_pk_bf16_f32 v81, v50, v51
    v_exp_f32 v54, v54
    v_exp_f32 v55, v55
    v_cvt_pk_bf16_f32 v82, v52, v53
    v_exp_f32 v56, v56
    v_exp_f32 v57, v57
    v_cvt_pk_bf16_f32 v83, v54, v55
    v_exp_f32 v58, v58
    v_exp_f32 v59, v59
    v_cvt_pk_bf16_f32 v84, v56, v57
    v_exp_f32 v60, v60
    v_exp_f32 v61, v61
    v_cvt_pk_bf16_f32 v85, v58, v59
    v_exp_f32 v62, v62
    v_exp_f32 v63, v63
    v_cvt_pk_bf16_f32 v86, v60, v61
    v_cvt_pk_bf16_f32 v87, v62, v63
    v_mfma_f32_32x32x16_bf16 v[88:103], v[24:27], v[80:83], 0
    s_nop 0
    v_mfma_f32_32x32x16_bf16 v[88:103], v[28:31], v[84:87], v[88:103]
    ds_read_b128 v[24:27], v125 offset:2048
    ds_read_b128 v[28:31], v125 offset:3072
    s_mov_b32 s23, s33
    s_mov_b32 s37, 0
    s_cmp_eq_u32 s23, 0
    s_cbranch_scc1 L_attnB_loopend
L_attnB_loop:
    s_waitcnt lgkmcnt(2)
    v_mfma_f32_32x32x16_bf16 v[48:63], v[16:19], v[8:11], v[104:119]
    v_mfma_f32_32x32x16_bf16 v[48:63], v[20:23], v[12:15], v[48:63]
    v_subrev_u32 v125, 0x1000, v125
    v_max_i32 v125, v125, v5
    ds_read_b128 v[16:19], v125
    ds_read_b128 v[20:23], v125 offset:1024
    s_sub_u32 s23, s23, 1
    s_nop 6
    v_exp_f32 v48, v48
    v_exp_f32 v49, v49
    v_exp_f32 v50, v50
    v_exp_f32 v51, v51
    v_cvt_pk_bf16_f32 v80, v48, v49
    v_exp_f32 v52, v52
    v_exp_f32 v53, v53
    v_cvt_pk_bf16_f32 v81, v50, v51
    v_exp_f32 v54, v54
    v_exp_f32 v55, v55
    v_cvt_pk_bf16_f32 v82, v52, v53
    v_exp_f32 v56, v56
    v_exp_f32 v57, v57
    v_cvt_pk_bf16_f32 v83, v54, v55
    v_exp_f32 v58, v58
    v_exp_f32 v59, v59
    v_cvt_pk_bf16_f32 v84, v56, v57
    v_exp_f32 v60, v60
    v_exp_f32 v61, v61
    v_cvt_pk_bf16_f32 v85, v58, v59
    v_exp_f32 v62, v62
    v_exp_f32 v63, v63
    v_cvt_pk_bf16_f32 v86, v60, v61
    v_cvt_pk_bf16_f32 v87, v62, v63
    s_waitcnt lgkmcnt(2)
    v_mfma_f32_32x32x16_bf16 v[88:103], v[24:27], v[80:83], v[88:103]
    v_mfma_f32_32x32x16_bf16 v[88:103], v[28:31], v[84:87], v[88:103]
    ds_read_b128 v[24:27], v125 offset:2048
    ds_read_b128 v[28:31], v125 offset:3072
    s_cmp_lg_u32 s23, 0
    s_cbranch_scc1 L_attnB_loop
L_attnB_loopend:
    s_cmp_eq_u32 s37, 1
    s_cbranch_scc1 L_attnB_f0done
    s_cmp_eq_u32 s37, 2
    s_cbranch_scc1 L_attnB_f1done
    s_waitcnt lgkmcnt(0)
    s_barrier
    v_add_u32 v125, 0x7000, v5
    ds_read_b128 v[16:19], v125
    ds_read_b128 v[20:23], v125 offset:1024
    ds_read_b128 v[24:27], v125 offset:2048
    ds_read_b128 v[28:31], v125 offset:3072
    s_mov_b32 s23, s36
    s_mov_b32 s37, 1
    s_branch L_attnB_loop
L_attnB_part1:
    v_mov_b32 v121, 0xf149f2ca
    v_sub_f32 v64, v121, v104
    v_sub_f32 v64, v64, v120
    v_sub_f32 v104, 0, v120
    v_sub_f32 v65, v121, v105
    v_sub_f32 v65, v65, v120
    v_sub_f32 v105, 0, v120
    v_sub_f32 v66, v121, v106
    v_sub_f32 v66, v66, v120
    v_sub_f32 v106, 0, v120
    v_sub_f32 v67, v121, v107
    v_sub_f32 v67, v67, v120
    v_sub_f32 v107, 0, v120
    v_sub_f32 v68, v121, v108
    v_sub_f32 v68, v68, v120
    v_sub_f32 v108, 0, v120
    v_sub_f32 v69, v121, v109
    v_sub_f32 v69, v69, v120
    v_sub_f32 v109, 0, v120
    v_sub_f32 v70, v121, v110
    v_sub_f32 v70, v70, v120
    v_sub_f32 v110, 0, v120
    v_sub_f32 v71, v121, v111
    v_sub_f32 v71, v71, v120
    v_sub_f32 v111, 0, v120
    v_sub_f32 v72, v121, v112
    v_sub_f32 v72, v72, v120
    v_sub_f32 v112, 0, v120
    v_sub_f32 v73, v121, v113
    v_sub_f32 v73, v73, v120
    v_sub_f32 v113, 0, v120
    v_sub_f32 v74, v121, v114
    v_sub_f32 v74, v74, v120
    v_sub_f32 v114, 0, v120
    v_sub_f32 v75, v121, v115
    v_sub_f32 v75, v75, v120
    v_sub_f32 v115, 0, v120
    v_sub_f32 v76, v121, v116
    v_sub_f32 v76, v76, v120
    v_sub_f32 v116, 0, v120
    v_sub_f32 v77, v121, v117
    v_sub_f32 v77, v77, v120
    v_sub_f32 v117, 0, v120
    v_sub_f32 v78, v121, v118
    v_sub_f32 v78, v78, v120
    v_sub_f32 v118, 0, v120
    v_sub_f32 v79, v121, v119
    v_sub_f32 v79, v79, v120
    v_sub_f32 v119, 0, v120
    s_lshl_b32 s24, s33, 12
    v_add_u32 v122, s24, v5
    s_lshl_b32 s24, s35, 12
    v_add_u32 v125, s24, v122
    s_waitcnt vmcnt(0) lgkmcnt(0)
    s_barrier
    ds_read_b128 v[16:19], v122
    ds_read_b128 v[20:23], v122 offset:1024
    ds_read_b128 v[24:27], v122 offset:2048
    ds_read_b128 v[28:31], v122 offset:3072
    s_mov_b32 s40, s21
    s_and_b32 s16, s14, 1
    s_lshl_b32 s15, s13, 1
    s_add_u32 s16, s16, s15
    s_lshr_b32 s17, s14, 1
    s_and_b32 s15, s12, 3
    s_lshl_b32 s18, s16, 2
    s_add_u32 s15, s15, s18
    s_cmp_ge_u32 s17, 14
    s_cbranch_scc1 Lpfp_mega_16
    s_lshl_b32 s21, s17, 15
    s_add_u32 s21, s21, 0x280000
    s_sub_u32 s57, s12, 4
    s_mul_i32 s57, s57, 8192
    s_add_u32 s57, s57, 0
    s_add_u32 s56, s21, s57
    s_add_u32 s57, s57, 131072
    s_add_u32 m0, s57, 0
    s_add_u32 s58, s56, 0
    buffer_load_dwordx4 v5, s[8:11], s58 offen offset:0 sc1 lds
    buffer_load_dwordx4 v5, s[8:11], s58 offen offset:1024 sc1 lds
    buffer_load_dwordx4 v5, s[8:11], s58 offen offset:2048 sc1 lds
    buffer_load_dwordx4 v5, s[8:11], s58 offen offset:3072 sc1 lds
    s_add_u32 m0, s57, 4096
    s_add_u32 s58, s56, 4096
    buffer_load_dwordx4 v5, s[8:11], s58 offen offset:0 sc1 lds
    buffer_load_dwordx4 v5, s[8:11], s58 offen offset:1024 sc1 lds
    buffer_load_dwordx4 v5, s[8:11], s58 offen offset:2048 sc1 lds
    buffer_load_dwordx4 v5, s[8:11], s58 offen offset:3072 sc1 lds
Lpfp_mega_16:
    s_cmp_lg_u32 s62, 0
    s_cbranch_scc1 L_attnB_nopfa
    s_and_b32 s16, s14, 1
    s_lshl_b32 s15, s13, 1
    s_add_u32 s16, s16, s15
    s_lshr_b32 s17, s14, 1
    s_and_b32 s15, s12, 3
    s_lshl_b32 s18, s16, 2
    s_add_u32 s15, s15, s18
    s_cmp_ge_u32 s17, 9
    s_cbranch_scc1 Lpfa_mega_17
    s_mul_i32 s21, s17, 59392
    s_add_u32 s21, s21, 0x0
    s_sub_u32 s57, s12, 4
    s_mul_i32 s57, s57, 15360
    s_add_u32 s57, s57, 0
    s_add_u32 s56, s21, s57
    s_add_u32 s57, s57, 32768
    s_add_u32 m0, s57, 0
    s_add_u32 s58, s56, 0
    buffer_load_dwordx4 v5, s[8:11], s58 offen offset:0 sc1 lds
    buffer_load_dwordx4 v5, s[8:11], s58 offen offset:1024 sc1 lds
    buffer_load_dwordx4 v5, s[8:11], s58 offen offset:2048 sc1 lds
    buffer_load_dwordx4 v5, s[8:11], s58 offen offset:3072 sc1 lds
    s_add_u32 m0, s57, 4096
    s_add_u32 s58, s56, 4096
    buffer_load_dwordx4 v5, s[8:11], s58 offen offset:0 sc1 lds
    buffer_load_dwordx4 v5, s[8:11], s58 offen offset:1024 sc1 lds
    buffer_load_dwordx4 v5, s[8:11], s58 offen offset:2048 sc1 lds
    buffer_load_dwordx4 v5, s[8:11], s58 offen offset:3072 sc1 lds
    s_add_u32 m0, s57, 8192
    s_add_u32 s58, s56, 8192
    buffer_load_dwordx4 v5, s[8:11], s58 offen offset:0 sc1 lds
    buffer_load_dwordx4 v5, s[8:11], s58 offen offset:1024 sc1 lds
    buffer_load_dwordx4 v5, s[8:11], s58 offen offset:2048 sc1 lds
    buffer_load_dwordx4 v5, s[8:11], s58 offen offset:3072 sc1 lds
    s_add_u32 m0, s57, 12288
    s_add_u32 s58, s56, 12288
    buffer_load_dwordx4 v5, s[8:11], s58 offen offset:0 sc1 lds
    s_cmp_eq_u32 s12, 7
    s_cbranch_scc1 Lpfs_mega_18
    buffer_load_dwordx4 v5, s[8:11], s58 offen offset:1024 sc1 lds
    buffer_load_dwordx4 v5, s[8:11], s58 offen offset:2048 sc1 lds
Lpfs_mega_18:
Lpfa_mega_17:
L_attnB_nopfa:
    s_mov_b32 s21, s40
    s_waitcnt lgkmcnt(2)
    v_mfma_f32_32x32x16_bf16 v[48:63], v[16:19], v[8:11], v[64:79]
    v_mfma_f32_32x32x16_bf16 v[48:63], v[20:23], v[12:15], v[48:63]
    ds_read_b128 v[16:19], v125
    ds_read_b128 v[20:23], v125 offset:1024
    s_nop 9
    v_exp_f32 v48, v48
    v_exp_f32 v49, v49
    v_exp_f32 v50, v50
    v_exp_f32 v51, v51
    v_cvt_pk_bf16_f32 v80, v48, v49
    v_exp_f32 v52, v52
    v_exp_f32 v53, v53
    v_cvt_pk_bf16_f32 v81, v50, v51
    v_exp_f32 v54, v54
    v_exp_f32 v55, v55
    v_cvt_pk_bf16_f32 v82, v52, v53
    v_exp_f32 v56, v56
    v_exp_f32 v57, v57
    v_cvt_pk_bf16_f32 v83, v54, v55
    v_exp_f32 v58, v58
    v_exp_f32 v59, v59
    v_cvt_pk_bf16_f32 v84, v56, v57
    v_exp_f32 v60, v60
    v_exp_f32 v61, v61
    v_cvt_pk_bf16_f32 v85, v58, v59
    v_exp_f32 v62, v62
    v_exp_f32 v63, v63
    v_cvt_pk_bf16_f32 v86, v60, v61
    v_cvt_pk_bf16_f32 v87, v62, v63
    s_waitcnt lgkmcnt(2)
    v_mfma_f32_32x32x16_bf16 v[88:103], v[24:27], v[80:83], 0
    v_mfma_f32_32x32x16_bf16 v[88:103], v[28:31], v[84:87], v[88:103]
    ds_read_b128 v[24:27], v125 offset:2048
    ds_read_b128 v[28:31], v125 offset:3072
    s_mov_b32 s23, s35
    s_mov_b32 s37, 2
    s_branch L_attnB_loop
L_attnB_f1done:
    s_lshl_b32 s24, s33, 12
    s_add_u32 s24, s24, 98304
    v_add_u32 v121, s24, v5
    v_mov_b32 v48, 0x53000000
    s_nop 7
    v_cmp_nlt_f32 vcc, v100, v48
    s_lshl_b32 s25, s12, 2
    s_add_u32 s25, s25, 94208
    v_mov_b32 v48, s25
    s_cmp_lg_u32 vcc_hi, 0
    s_cselect_b32 s25, 1, 0
    v_mov_b32 v49, s25
    ds_write_b32 v48, v49
    ds_write_b128 v121, v[88:91] offset:0
    ds_write_b128 v121, v[92:95] offset:1024
    ds_write_b128 v121, v[96:99] offset:2048
    ds_write_b128 v121, v[100:103] offset:3072
    s_waitcnt lgkmcnt(0)
    s_barrier
    s_branch L_attnB_sig
L_attnB_f0done:
    s_lshl_b32 s24, s33, 12
    s_add_u32 s24, s24, 98304
    v_add_u32 v121, s24, v5
    v_mov_b32 v48, 0x53000000
    s_nop 7
    v_cmp_nlt_f32 vcc, v100, v48
    s_lshl_b32 s25, s12, 2
    s_add_u32 s25, s25, 94208
    v_mov_b32 v48, s25
    s_cmp_lg_u32 vcc_hi, 0
    s_cselect_b32 s25, 1, 0
    v_mov_b32 v49, s25
    ds_write_b32 v48, v49
    s_waitcnt lgkmcnt(0)
    s_barrier
    ds_read_b128 v[64:67], v121 offset:0
    ds_read_b128 v[68:71], v121 offset:1024
    ds_read_b128 v[72:75], v121 offset:2048
    ds_read_b128 v[76:79], v121 offset:3072
    v_and_b32 v48, 7, v2
    v_lshlrev_b32 v48, 2, v48
    v_add_u32 v48, 94208, v48
    ds_read_b32 v49, v48
    s_waitcnt lgkmcnt(0)
    v_cmp_ne_u32 vcc, 0, v49
    s_nop 1
    s_or_b32 s25, vcc_lo, vcc_hi
    s_cmp_lg_u32 s25, 0
    s_cbranch_scc1 L_attnB_exact
    v_add_f32 v88, v88, v64
    v_add_f32 v89, v89, v65
    v_add_f32 v90, v90, v66
    v_add_f32 v91, v91, v67
    v_add_f32 v92, v92, v68
    v_add_f32 v93, v93, v69
    v_add_f32 v94, v94, v70
    v_add_f32 v95, v95, v71
    v_add_f32 v96, v96, v72
    v_add_f32 v97, v97, v73
    v_add_f32 v98, v98, v74
    v_add_f32 v99, v99, v75
    v_add_f32 v100, v100, v76
    v_add_f32 v101, v101, v77
    v_add_f32 v102, v102, v78
    v_add_f32 v103, v103, v79
L_attnB_fin:
    v_mov_b32 v121, v100
    v_mov_b32 v122, v100
    s_nop 1
    v_permlane32_swap_b32 v121, v122
    v_rcp_f32 v122, v122
    v_cmp_eq_u32 vcc, 0, v4
    s_nop 1
    v_cndmask_b32 v121, 0, -1, vcc
    v_mul_f32 v88, v88, v122
    v_mul_f32 v89, v89, v122
    v_mul_f32 v90, v90, v122
    v_mul_f32 v91, v91, v122
    v_mul_f32 v92, v92, v122
    v_mul_f32 v93, v93, v122
    v_mul_f32 v94, v94, v122
    v_mul_f32 v95, v95, v122
    v_mul_f32 v96, v96, v122
    v_mul_f32 v97, v97, v122
    v_mul_f32 v98, v98, v122
    v_mul_f32 v99, v99, v122
    v_mul_f32 v100, v100, v122
    v_mul_f32 v101, v101, v122
    v_mul_f32 v102, v102, v122
    v_mul_f32 v103, v103, v122
    v_cvt_pk_bf16_f32 v80, v88, v89
    v_cvt_pk_bf16_f32 v81, v90, v91
    v_cvt_pk_bf16_f32 v82, v92, v93
    v_cvt_pk_bf16_f32 v83, v94, v95
    v_cvt_pk_bf16_f32 v84, v96, v97
    v_cvt_pk_bf16_f32 v85, v98, v99
    v_cvt_pk_bf16_f32 v86, v100, v101
    v_cvt_pk_bf16_f32 v87, v102, v103
    v_and_b32 v86, v86, v121
    v_and_b32 v87, v87, v121
    s_cmp_lg_u32 s68, 0
    s_cbranch_scc1 Lls_mega_19_loc
    buffer_store_dwordx4 v[80:83], v5, s[8:11], s17 offen sc1
    buffer_store_dwordx4 v[84:87], v5, s[8:11], s17 offen offset:1024 sc1
    s_branch Lls_mega_19_end
Lls_mega_19_loc:
    buffer_store_dwordx4 v[80:83], v5, s[8:11], s17 offen
    buffer_store_dwordx4 v[84:87], v5, s[8:11], s17 offen offset:1024
Lls_mega_19_end:
    s_branch L_attnB_sig
L_attnB_exact:
    v_add_u32 v122, 110592, v5
    v_add_u32 v123, 0x7000, v5
    v_lshlrev_b32 v120, 2, v4
    v_sub_u32 v120, v3, v120
    v_mov_b32 v121, 0xf149f2ca
    s_min_u32 s22, s15, 7
    v_cmp_le_i32 vcc, 0, v120
    s_nop 1
    v_cndmask_b32 v64, v121, 0, vcc
    v_cndmask_b32 v32, 0, v121, vcc
    v_cmp_le_i32 vcc, 1, v120
    s_nop 1
    v_cndmask_b32 v65, v121, 0, vcc
    v_cndmask_b32 v33, 0, v121, vcc
    v_cmp_le_i32 vcc, 2, v120
    s_nop 1
    v_cndmask_b32 v66, v121, 0, vcc
    v_cndmask_b32 v34, 0, v121, vcc
    v_cmp_le_i32 vcc, 3, v120
    s_nop 1
    v_cndmask_b32 v67, v121, 0, vcc
    v_cndmask_b32 v35, 0, v121, vcc
    v_cmp_le_i32 vcc, 8, v120
    s_nop 1
    v_cndmask_b32 v68, v121, 0, vcc
    v_cndmask_b32 v36, 0, v121, vcc
    v_cmp_le_i32 vcc, 9, v120
    s_nop 1
    v_cndmask_b32 v69, v121, 0, vcc
    v_cndmask_b32 v37, 0, v121, vcc
    v_cmp_le_i32 vcc, 10, v120
    s_nop 1
    v_cndmask_b32 v70, v121, 0, vcc
    v_cndmask_b32 v38, 0, v121, vcc
    v_cmp_le_i32 vcc, 11, v120
    s_nop 1
    v_cndmask_b32 v71, v121, 0, vcc
    v_cndmask_b32 v39, 0, v121, vcc
    v_cmp_le_i32 vcc, 16, v120
    s_nop 1
    v_cndmask_b32 v72, v121, 0, vcc
    v_cndmask_b32 v40, 0, v121, vcc
    v_cmp_le_i32 vcc, 17, v120
    s_nop 1
    v_cndmask_b32 v73, v121, 0, vcc
    v_cndmask_b32 v41, 0, v121, vcc
    v_cmp_le_i32 vcc, 18, v120
    s_nop 1
    v_cndmask_b32 v74, v121, 0, vcc
    v_cndmask_b32 v42, 0, v121, vcc
    v_cmp_le_i32 vcc, 19, v120
    s_nop 1
    v_cndmask_b32 v75, v121, 0, vcc
    v_cndmask_b32 v43, 0, v121, vcc
    v_cmp_le_i32 vcc, 24, v120
    s_nop 1
    v_cndmask_b32 v76, v121, 0, vcc
    v_cndmask_b32 v44, 0, v121, vcc
    v_cmp_le_i32 vcc, 25, v120
    s_nop 1
    v_cndmask_b32 v77, v121, 0, vcc
    v_cndmask_b32 v45, 0, v121, vcc
    v_cmp_le_i32 vcc, 26, v120
    s_nop 1
    v_cndmask_b32 v78, v121, 0, vcc
    v_cndmask_b32 v46, 0, v121, vcc
    v_cmp_le_i32 vcc, 27, v120
    s_nop 1
    v_cndmask_b32 v79, v121, 0, vcc
    v_cndmask_b32 v47, 0, v121, vcc
    ds_read_b128 v[16:19], v124
    ds_read_b128 v[20:23], v124 offset:1024
    s_waitcnt lgkmcnt(0)
    v_mfma_f32_32x32x16_bf16 v[48:63], v[16:19], v[8:11], v[64:79]
    v_mfma_f32_32x32x16_bf16 v[48:63], v[20:23], v[12:15], v[48:63]
    s_nop 11
    v_max3_f32 v120, v48, v49, v50
    v_max3_f32 v120, v120, v51, v52
    v_max3_f32 v120, v120, v53, v54
    v_max3_f32 v120, v120, v55, v56
    v_max3_f32 v120, v120, v57, v58
    v_max3_f32 v120, v120, v59, v60
    v_max3_f32 v120, v120, v61, v62
    v_max_f32 v120, v120, v63
    v_mov_b32 v125, v124
    s_mov_b32 s23, s22
    s_cmp_eq_u32 s23, 0
    s_cbranch_scc1 L_attnB_p1far
L_attnB_p1loop:
    v_subrev_u32 v125, 0x1000, v125
    v_cmp_eq_u32 vcc, v125, v122
    s_nop 1
    v_cndmask_b32 v125, v125, v123, vcc
    ds_read_b128 v[16:19], v125
    ds_read_b128 v[20:23], v125 offset:1024
    s_waitcnt lgkmcnt(0)
    v_mfma_f32_32x32x16_bf16 v[48:63], v[16:19], v[8:11], 0
    v_mfma_f32_32x32x16_bf16 v[48:63], v[20:23], v[12:15], v[48:63]
    s_nop 11
    v_max3_f32 v120, v120, v48, v49
    v_max3_f32 v120, v120, v50, v51
    v_max3_f32 v120, v120, v52, v53
    v_max3_f32 v120, v120, v54, v55
    v_max3_f32 v120, v120, v56, v57
    v_max3_f32 v120, v120, v58, v59
    v_max3_f32 v120, v120, v60, v61
    v_max3_f32 v120, v120, v62, v63
    s_sub_u32 s23, s23, 1
    s_cmp_lg_u32 s23, 0
    s_cbranch_scc1 L_attnB_p1loop
L_attnB_p1far:
    s_cmp_lt_u32 s15, 8
    s_cbranch_scc1 L_attnB_p1done
    v_subrev_u32 v125, 0x1000, v125
    v_cmp_eq_u32 vcc, v125, v122
    s_nop 1
    v_cndmask_b32 v125, v125, v123, vcc
    ds_read_b128 v[16:19], v125
    ds_read_b128 v[20:23], v125 offset:1024
    s_waitcnt lgkmcnt(0)
    v_mfma_f32_32x32x16_bf16 v[48:63], v[16:19], v[8:11], v[32:47]
    v_mfma_f32_32x32x16_bf16 v[48:63], v[20:23], v[12:15], v[48:63]
    s_nop 11
    v_max3_f32 v120, v120, v48, v49
    v_max3_f32 v120, v120, v50, v51
    v_max3_f32 v120, v120, v52, v53
    v_max3_f32 v120, v120, v54, v55
    v_max3_f32 v120, v120, v56, v57
    v_max3_f32 v120, v120, v58, v59
    v_max3_f32 v120, v120, v60, v61
    v_max3_f32 v120, v120, v62, v63
L_attnB_p1done:
    v_mov_b32 v121, v120
    s_nop 1
    v_permlane32_swap_b32 v120, v121
    v_max_f32 v120, v120, v121
    v_sub_f32 v104, 0, v120
    v_sub_f32 v64, v64, v120
    v_sub_f32 v32, v32, v120
    v_sub_f32 v105, 0, v120
    v_sub_f32 v65, v65, v120
    v_sub_f32 v33, v33, v120
    v_sub_f32 v106, 0, v120
    v_sub_f32 v66, v66, v120
    v_sub_f32 v34, v34, v120
    v_sub_f32 v107, 0, v120
    v_sub_f32 v67, v67, v120
    v_sub_f32 v35, v35, v120
    v_sub_f32 v108, 0, v120
    v_sub_f32 v68, v68, v120
    v_sub_f32 v36, v36, v120
    v_sub_f32 v109, 0, v120
    v_sub_f32 v69, v69, v120
    v_sub_f32 v37, v37, v120
    v_sub_f32 v110, 0, v120
    v_sub_f32 v70, v70, v120
    v_sub_f32 v38, v38, v120
    v_sub_f32 v111, 0, v120
    v_sub_f32 v71, v71, v120
    v_sub_f32 v39, v39, v120
    v_sub_f32 v112, 0, v120
    v_sub_f32 v72, v72, v120
    v_sub_f32 v40, v40, v120
    v_sub_f32 v113, 0, v120
    v_sub_f32 v73, v73, v120
    v_sub_f32 v41, v41, v120
    v_sub_f32 v114, 0, v120
    v_sub_f32 v74, v74, v120
    v_sub_f32 v42, v42, v120
    v_sub_f32 v115, 0, v120
    v_sub_f32 v75, v75, v120
    v_sub_f32 v43, v43, v120
    v_sub_f32 v116, 0, v120
    v_sub_f32 v76, v76, v120
    v_sub_f32 v44, v44, v120
    v_sub_f32 v117, 0, v120
    v_sub_f32 v77, v77, v120
    v_sub_f32 v45, v45, v120
    v_sub_f32 v118, 0, v120
    v_sub_f32 v78, v78, v120
    v_sub_f32 v46, v46, v120
    v_sub_f32 v119, 0, v120
    v_sub_f32 v79, v79, v120
    v_sub_f32 v47, v47, v120
    ds_read_b128 v[16:19], v124
    ds_read_b128 v[20:23], v124 offset:1024
    s_waitcnt lgkmcnt(0)
    v_mfma_f32_32x32x16_bf16 v[48:63], v[16:19], v[8:11], v[64:79]
    v_mfma_f32_32x32x16_bf16 v[48:63], v[20:23], v[12:15], v[48:63]
    ds_read_b128 v[24:27], v124 offset:2048
    ds_read_b128 v[28:31], v124 offset:3072
    s_nop 9
    v_exp_f32 v48, v48
    v_exp_f32 v49, v49
    v_exp_f32 v50, v50
    v_exp_f32 v51, v51
    v_exp_f32 v52, v52
    v_exp_f32 v53, v53
    v_exp_f32 v54, v54
    v_exp_f32 v55, v55
    v_exp_f32 v56, v56
    v_exp_f32 v57, v57
    v_exp_f32 v58, v58
    v_exp_f32 v59, v59
    v_exp_f32 v60, v60
    v_exp_f32 v61, v61
    v_exp_f32 v62, v62
    v_exp_f32 v63, v63
    v_cvt_pk_bf16_f32 v80, v48, v49
    v_cvt_pk_bf16_f32 v81, v50, v51
    v_cvt_pk_bf16_f32 v82, v52, v53
    v_cvt_pk_bf16_f32 v83, v54, v55
    v_cvt_pk_bf16_f32 v84, v56, v57
    v_cvt_pk_bf16_f32 v85, v58, v59
    v_cvt_pk_bf16_f32 v86, v60, v61
    v_cvt_pk_bf16_f32 v87, v62, v63
    s_waitcnt lgkmcnt(0)
    v_mfma_f32_32x32x16_bf16 v[88:103], v[24:27], v[80:83], 0
    v_mfma_f32_32x32x16_bf16 v[88:103], v[28:31], v[84:87], v[88:103]
    v_mov_b32 v125, v124
    s_mov_b32 s23, s22
    s_cmp_eq_u32 s23, 0
    s_cbranch_scc1 L_attnB_p2far
L_attnB_p2loop:
    v_subrev_u32 v125, 0x1000, v125
    v_cmp_eq_u32 vcc, v125, v122
    s_nop 1
    v_cndmask_b32 v125, v125, v123, vcc
    ds_read_b128 v[16:19], v125
    ds_read_b128 v[20:23], v125 offset:1024
    s_waitcnt lgkmcnt(0)
    v_mfma_f32_32x32x16_bf16 v[48:63], v[16:19], v[8:11], v[104:119]
    v_mfma_f32_32x32x16_bf16 v[48:63], v[20:23], v[12:15], v[48:63]
    ds_read_b128 v[24:27], v125 offset:2048
    ds_read_b128 v[28:31], v125 offset:3072
    s_nop 9
    v_exp_f32 v48, v48
    v_exp_f32 v49, v49
    v_exp_f32 v50, v50
    v_exp_f32 v51, v51
    v_exp_f32 v52, v52
    v_exp_f32 v53, v53
    v_exp_f32 v54, v54
    v_exp_f32 v55, v55
    v_exp_f32 v56, v56
    v_exp_f32 v57, v57
    v_exp_f32 v58, v58
    v_exp_f32 v59, v59
    v_exp_f32 v60, v60
    v_exp_f32 v61, v61
    v_exp_f32 v62, v62
    v_exp_f32 v63, v63
    v_cvt_pk_bf16_f32 v80, v48, v49
    v_cvt_pk_bf16_f32 v81, v50, v51
    v_cvt_pk_bf16_f32 v82, v52, v53
    v_cvt_pk_bf16_f32 v83, v54, v55
    v_cvt_pk_bf16_f32 v84, v56, v57
    v_cvt_pk_bf16_f32 v85, v58, v59
    v_cvt_pk_bf16_f32 v86, v60, v61
    v_cvt_pk_bf16_f32 v87, v62, v63
    s_waitcnt lgkmcnt(0)
    v_mfma_f32_32x32x16_bf16 v[88:103], v[24:27], v[80:83], v[88:103]
    v_mfma_f32_32x32x16_bf16 v[88:103], v[28:31], v[84:87], v[88:103]
    s_sub_u32 s23, s23, 1
    s_cmp_lg_u32 s23, 0
    s_cbranch_scc1 L_attnB_p2loop
L_attnB_p2far:
    s_cmp_lt_u32 s15, 8
    s_cbranch_scc1 L_attnB_p2done
    v_subrev_u32 v125, 0x1000, v125
    v_cmp_eq_u32 vcc, v125, v122
    s_nop 1
    v_cndmask_b32 v125, v125, v123, vcc
    ds_read_b128 v[16:19], v125
    ds_read_b128 v[20:23], v125 offset:1024
    s_waitcnt lgkmcnt(0)
    v_mfma_f32_32x32x16_bf16 v[48:63], v[16:19], v[8:11], v[32:47]
    v_mfma_f32_32x32x16_bf16 v[48:63], v[20:23], v[12:15], v[48:63]
    ds_read_b128 v[24:27], v125 offset:2048
    ds_read_b128 v[28:31], v125 offset:3072
    s_nop 9
    v_exp_f32 v48, v48
    v_exp_f32 v49, v49
    v_exp_f32 v50, v50
    v_exp_f32 v51, v51
    v_exp_f32 v52, v52
    v_exp_f32 v53, v53
    v_exp_f32 v54, v54
    v_exp_f32 v55, v55
    v_exp_f32 v56, v56
    v_exp_f32 v57, v57
    v_exp_f32 v58, v58
    v_exp_f32 v59, v59
    v_exp_f32 v60, v60
    v_exp_f32 v61, v61
    v_exp_f32 v62, v62
    v_exp_f32 v63, v63
    v_cvt_pk_bf16_f32 v80, v48, v49
    v_cvt_pk_bf16_f32 v81, v50, v51
    v_cvt_pk_bf16_f32 v82, v52, v53
    v_cvt_pk_bf16_f32 v83, v54, v55
    v_cvt_pk_bf16_f32 v84, v56, v57
    v_cvt_pk_bf16_f32 v85, v58, v59
    v_cvt_pk_bf16_f32 v86, v60, v61
    v_cvt_pk_bf16_f32 v87, v62, v63
    s_waitcnt lgkmcnt(0)
    v_mfma_f32_32x32x16_bf16 v[88:103], v[24:27], v[80:83], v[88:103]
    v_mfma_f32_32x32x16_bf16 v[88:103], v[28:31], v[84:87], v[88:103]
L_attnB_p2done:
    s_nop 15
    s_branch L_attnB_fin
L_attnB_sig:
    s_lshl_b32 s19, s20, 4
    s_add_u32 s19, s19, s21
    s_waitcnt vmcnt(0) lgkmcnt(0)
    s_barrier
    s_cmp_lg_u32 s12, 0
    s_cbranch_scc1 Lsab_mega_20
    s_lshl_b32 s58, s19, 7
    s_add_u32 s58, s58, s61
    s_add_u32 s58, s58, 262144
    v_mov_b32 v125, 0
    v_mov_b32 v126, s66
    v_mov_b32 v127, s67
    s_mov_b64 exec, 1
    s_cmp_lg_u32 s68, 0
    s_cbranch_scc1 Lls_mega_21_loc
    buffer_store_dwordx2 v[126:127], v125, s[8:11], s58 offen sc1
    s_branch Lls_mega_21_end
Lls_mega_21_loc:
    buffer_store_dwordx2 v[126:127], v125, s[8:11], s58 offen
Lls_mega_21_end:
    s_mov_b64 exec, -1
Lsab_mega_20:
    s_and_b32 s16, s14, 1
    s_lshl_b32 s15, s13, 1
    s_add_u32 s16, s16, s15
    s_lshr_b32 s17, s14, 1
    s_and_b32 s15, s12, 3
    s_lshl_b32 s18, s16, 2
    s_add_u32 s15, s15, s18
    s_cmp_ge_u32 s17, 14
    s_cbranch_scc1 L_prjB_end
    s_lshl_b32 s19, s16, 4
    s_lshl_b32 s20, s15, 15
    s_add_u32 s20, s20, s60
    s_add_u32 s20, s20, 0x800000
    s_mul_i32 s30, s15, 28672
    s_lshl_b32 s31, s17, 11
    s_add_u32 s30, s30, s31
    s_add_u32 s30, s30, s60
    s_cmp_lg_u32 s12, 0
    s_cbranch_scc1 LwprjB_mega_22_skip
    v_min_u32 v11, 15, v2
    v_lshlrev_b32 v11, 7, v11
    s_lshl_b32 s58, s19, 7
    s_add_u32 s58, s58, s61
    s_add_u32 s58, s58, 0x40000
    s_mov_b32 s59, 0
LwprjB_mega_22:
    buffer_load_dwordx2 v[12:13], v11, s[8:11], s58 offen sc1
    s_add_u32 s59, s59, 1
    s_waitcnt vmcnt(0)
    v_cmp_ne_u64 vcc, s[66:67], v[12:13]
    s_cmp_ge_u32 s59, 0x8000
    s_cbranch_scc1 LwprjB_mega_22_t
    s_nop 0
    s_cbranch_vccnz LwprjB_mega_22
LwprjB_mega_22_t:
LwprjB_mega_22_skip:
    s_waitcnt vmcnt(0)
    s_barrier
    s_cmp_ge_u32 s12, 4
    s_cbranch_scc1 L_prjB_sig
    s_add_u32 s25, s20, 0
    buffer_load_dwordx4 a[0:3], v5, s[8:11], s25 offen offset:0 sc1
    buffer_load_dwordx4 a[4:7], v5, s[8:11], s25 offen offset:1024 sc1
    buffer_load_dwordx4 a[8:11], v5, s[8:11], s25 offen offset:2048 sc1
    buffer_load_dwordx4 a[12:15], v5, s[8:11], s25 offen offset:3072 sc1
    buffer_load_dwordx4 v[88:91], v5, s[8:11], s30 offen sc1
    buffer_load_dwordx4 v[92:95], v5, s[8:11], s30 offen offset:1024 sc1
    s_add_u32 s25, s20, 4096
    buffer_load_dwordx4 a[16:19], v5, s[8:11], s25 offen offset:0 sc1
    buffer_load_dwordx4 a[20:23], v5, s[8:11], s25 offen offset:1024 sc1
    buffer_load_dwordx4 a[24:27], v5, s[8:11], s25 offen offset:2048 sc1
    buffer_load_dwordx4 a[28:31], v5, s[8:11], s25 offen offset:3072 sc1
    ds_read_b128 v[16:19], v7 offset:0
    ds_read_b128 v[20:23], v7 offset:1024
    ds_read_b128 v[24:27], v7 offset:2048
    ds_read_b128 v[28:31], v7 offset:3072
    ds_read_b128 v[32:35], v7 offset:4096
    s_waitcnt vmcnt(6)
    ds_read_b128 v[36:39], v7 offset:5120
    s_waitcnt lgkmcnt(5)
    v_mfma_f32_32x32x16_bf16 v[40:55], v[16:19], a[0:3], 0
    s_add_u32 s25, s20, 8192
    buffer_load_dwordx4 a[32:35], v5, s[8:11], s25 offen offset:0 sc1
    ds_read_b128 v[16:19], v7 offset:6144
    s_waitcnt lgkmcnt(5)
    v_mfma_f32_32x32x16_bf16 v[40:55], v[20:23], a[4:7], v[40:55]
    buffer_load_dwordx4 a[36:39], v5, s[8:11], s25 offen offset:1024 sc1
    ds_read_b128 v[20:23], v7 offset:7168
    s_waitcnt lgkmcnt(5)
    v_mfma_f32_32x32x16_bf16 v[40:55], v[24:27], a[8:11], v[40:55]
    buffer_load_dwordx4 a[40:43], v5, s[8:11], s25 offen offset:2048 sc1
    ds_read_b128 v[24:27], v7 offset:8192
    s_waitcnt lgkmcnt(5)
    v_mfma_f32_32x32x16_bf16 v[40:55], v[28:31], a[12:15], v[40:55]
    buffer_load_dwordx4 a[44:47], v5, s[8:11], s25 offen offset:3072 sc1
    s_waitcnt vmcnt(4)
    ds_read_b128 v[28:31], v7 offset:9216
    s_waitcnt lgkmcnt(5)
    v_mfma_f32_32x32x16_bf16 v[40:55], v[32:35], a[16:19], v[40:55]
    s_add_u32 s25, s20, 12288
    buffer_load_dwordx4 a[48:51], v5, s[8:11], s25 offen offset:0 sc1
    ds_read_b128 v[32:35], v7 offset:10240
    s_waitcnt lgkmcnt(5)
    v_mfma_f32_32x32x16_bf16 v[40:55], v[36:39], a[20:23], v[40:55]
    buffer_load_dwordx4 a[52:55], v5, s[8:11], s25 offen offset:1024 sc1
    ds_read_b128 v[36:39], v7 offset:11264
    s_waitcnt lgkmcnt(5)
    v_mfma_f32_32x32x16_bf16 v[40:55], v[16:19], a[24:27], v[40:55]
    buffer_load_dwordx4 a[56:59], v5, s[8:11], s25 offen offset:2048 sc1
    ds_read_b128 v[16:19], v7 offset:12288
    s_waitcnt lgkmcnt(5)
    v_mfma_f32_32x32x16_bf16 v[40:55], v[20:23], a[28:31], v[40:55]
    buffer_load_dwordx4 a[60:63], v5, s[8:11], s25 offen offset:3072 sc1
    s_waitcnt vmcnt(4)
    ds_read_b128 v[20:23], v7 offset:13312
    s_waitcnt lgkmcnt(5)
    v_mfma_f32_32x32x16_bf16 v[40:55], v[24:27], a[32:35], v[40:55]
    s_add_u32 s25, s20, 16384
    buffer_load_dwordx4 a[64:67], v5, s[8:11], s25 offen offset:0 sc1
    ds_read_b128 v[24:27], v7 offset:14336
    s_waitcnt lgkmcnt(5)
    v_mfma_f32_32x32x16_bf16 v[40:55], v[28:31], a[36:39], v[40:55]
    buffer_load_dwordx4 a[68:71], v5, s[8:11], s25 offen offset:1024 sc1
    ds_read_b128 v[28:31], v7 offset:15360
    s_waitcnt lgkmcnt(5)
    v_mfma_f32_32x32x16_bf16 v[40:55], v[32:35], a[40:43], v[40:55]
    buffer_load_dwordx4 a[72:75], v5, s[8:11], s25 offen offset:2048 sc1
    ds_read_b128 v[32:35], v7 offset:16384
    s_waitcnt lgkmcnt(5)
    v_mfma_f32_32x32x16_bf16 v[40:55], v[36:39], a[44:47], v[40:55]
    buffer_load_dwordx4 a[76:79], v5, s[8:11], s25 offen offset:3072 sc1
    s_waitcnt vmcnt(4)
    ds_read_b128 v[36:39], v7 offset:17408
    s_waitcnt lgkmcnt(5)
    v_mfma_f32_32x32x16_bf16 v[40:55], v[16:19], a[48:51], v[40:55]
    s_add_u32 s25, s20, 20480
    buffer_load_dwordx4 a[80:83], v5, s[8:11], s25 offen offset:0 sc1
    ds_read_b128 v[16:19], v7 offset:18432
    s_waitcnt lgkmcnt(5)
    v_mfma_f32_32x32x16_bf16 v[40:55], v[20:23], a[52:55], v[40:55]
    buffer_load_dwordx4 a[84:87], v5, s[8:11], s25 offen offset:1024 sc1
    ds_read_b128 v[20:23], v7 offset:19456
    s_waitcnt lgkmcnt(5)
    v_mfma_f32_32x32x16_bf16 v[40:55], v[24:27], a[56:59], v[40:55]
    buffer_load_dwordx4 a[88:91], v5, s[8:11], s25 offen offset:2048 sc1
    ds_read_b128 v[24:27], v7 offset:20480
    s_waitcnt lgkmcnt(5)
    v_mfma_f32_32x32x16_bf16 v[40:55], v[28:31], a[60:63], v[40:55]
    buffer_load_dwordx4 a[92:95], v5, s[8:11], s25 offen offset:3072 sc1
    s_waitcnt vmcnt(4)
    ds_read_b128 v[28:31], v7 offset:21504
    s_waitcnt lgkmcnt(5)
    v_mfma_f32_32x32x16_bf16 v[40:55], v[32:35], a[64:67], v[40:55]
    s_add_u32 s25, s20, 24576
    buffer_load_dwordx4 a[96:99], v5, s[8:11], s25 offen offset:0 sc1
    ds_read_b128 v[32:35], v7 offset:22528
    s_waitcnt lgkmcnt(5)
    v_mfma_f32_32x32x16_bf16 v[40:55], v[36:39], a[68:71], v[40:55]
    buffer_load_dwordx4 a[100:103], v5, s[8:11], s25 offen offset:1024 sc1
    ds_read_b128 v[36:39], v7 offset:23552
    s_waitcnt lgkmcnt(5)
    v_mfma_f32_32x32x16_bf16 v[40:55], v[16:19], a[72:75], v[40:55]
    buffer_load_dwordx4 a[104:107], v5, s[8:11], s25 offen offset:2048 sc1
    ds_read_b128 v[16:19], v7 offset:24576
    s_waitcnt lgkmcnt(5)
    v_mfma_f32_32x32x16_bf16 v[40:55], v[20:23], a[76:79], v[40:55]
    buffer_load_dwordx4 a[108:111], v5, s[8:11], s25 offen offset:3072 sc1
    s_waitcnt vmcnt(4)
    ds_read_b128 v[20:23], v7 offset:25600
    s_waitcnt lgkmcnt(5)
    v_mfma_f32_32x32x16_bf16 v[40:55], v[24:27], a[80:83], v[40:55]
    s_add_u32 s25, s20, 28672
    buffer_load_dwordx4 a[112:115], v5, s[8:11], s25 offen offset:0 sc1
    ds_read_b128 v[24:27], v7 offset:26624
    s_waitcnt lgkmcnt(5)
    v_mfma_f32_32x32x16_bf16 v[40:55], v[28:31], a[84:87], v[40:55]
    buffer_load_dwordx4 a[116:119], v5, s[8:11], s25 offen offset:1024 sc1
    ds_read_b128 v[28:31], v7 offset:27648
    s_waitcnt lgkmcnt(5)
    v_mfma_f32_32x32x16_bf16 v[40:55], v[32:35], a[88:91], v[40:55]
    buffer_load_dwordx4 a[120:123], v5, s[8:11], s25 offen offset:2048 sc1
    ds_read_b128 v[32:35], v7 offset:28672
    s_waitcnt lgkmcnt(5)
    v_mfma_f32_32x32x16_bf16 v[40:55], v[36:39], a[92:95], v[40:55]
    buffer_load_dwordx4 a[124:127], v5, s[8:11], s25 offen offset:3072 sc1
    s_waitcnt vmcnt(4)
    ds_read_b128 v[36:39], v7 offset:29696
    s_waitcnt lgkmcnt(5)
    v_mfma_f32_32x32x16_bf16 v[40:55], v[16:19], a[96:99], v[40:55]
    ds_read_b128 v[16:19], v7 offset:30720
    s_waitcnt lgkmcnt(5)
    v_mfma_f32_32x32x16_bf16 v[40:55], v[20:23], a[100:103], v[40:55]
    ds_read_b128 v[20:23], v7 offset:31744
    s_waitcnt lgkmcnt(5)
    v_mfma_f32_32x32x16_bf16 v[40:55], v[24:27], a[104:107], v[40:55]
    s_waitcnt lgkmcnt(4)
    v_mfma_f32_32x32x16_bf16 v[40:55], v[28:31], a[108:111], v[40:55]
    s_waitcnt vmcnt(0)
    s_waitcnt lgkmcnt(3)
    v_mfma_f32_32x32x16_bf16 v[40:55], v[32:35], a[112:115], v[40:55]
    s_waitcnt lgkmcnt(2)
    v_mfma_f32_32x32x16_bf16 v[40:55], v[36:39], a[116:119], v[40:55]
    s_waitcnt lgkmcnt(1)
    v_mfma_f32_32x32x16_bf16 v[40:55], v[16:19], a[120:123], v[40:55]
    s_waitcnt lgkmcnt(0)
    v_mfma_f32_32x32x16_bf16 v[40:55], v[20:23], a[124:127], v[40:55]
    v_lshlrev_b32 v10, 16, v88
    v_and_b32 v11, 0xffff0000, v88
    s_nop 9
    v_add_f32 v40, v40, v10
    v_add_f32 v41, v41, v11
    v_cvt_pk_bf16_f32 v88, v40, v41
    v_lshlrev_b32 v10, 16, v89
    v_and_b32 v11, 0xffff0000, v89
    v_add_f32 v42, v42, v10
    v_add_f32 v43, v43, v11
    v_cvt_pk_bf16_f32 v89, v42, v43
    v_lshlrev_b32 v10, 16, v90
    v_and_b32 v11, 0xffff0000, v90
    v_add_f32 v44, v44, v10
    v_add_f32 v45, v45, v11
    v_cvt_pk_bf16_f32 v90, v44, v45
    v_lshlrev_b32 v10, 16, v91
    v_and_b32 v11, 0xffff0000, v91
    v_add_f32 v46, v46, v10
    v_add_f32 v47, v47, v11
    v_cvt_pk_bf16_f32 v91, v46, v47
    v_lshlrev_b32 v10, 16, v92
    v_and_b32 v11, 0xffff0000, v92
    v_add_f32 v48, v48, v10
    v_add_f32 v49, v49, v11
    v_cvt_pk_bf16_f32 v92, v48, v49
    v_lshlrev_b32 v10, 16, v93
    v_and_b32 v11, 0xffff0000, v93
    v_add_f32 v50, v50, v10
    v_add_f32 v51, v51, v11
    v_cvt_pk_bf16_f32 v93, v50, v51
    v_lshlrev_b32 v10, 16, v94
    v_and_b32 v11, 0xffff0000, v94
    v_add_f32 v52, v52, v10
    v_add_f32 v53, v53, v11
    v_cvt_pk_bf16_f32 v94, v52, v53
    v_lshlrev_b32 v10, 16, v95
    v_and_b32 v11, 0xffff0000, v95
    v_add_f32 v54, v54, v10
    v_add_f32 v55, v55, v11
    v_cvt_pk_bf16_f32 v95, v54, v55
    s_cmp_eq_u32 s62, 0
    s_cbranch_scc1 L_prjB_mid
    s_mov_b64 s[4:5], s[46:47]
    s_mov_b32 s6, 1835008
    s_mov_b32 s7, 0x00020000
    s_lshl_b32 s26, s15, 5
    v_add_u32 v10, s26, v3
    v_mul_u32_u24 v10, 896, v10
    v_lshl_add_u32 v10, v4, 4, v10
    s_lshl_b32 s31, s17, 6
    v_permlane32_swap_b32 v88, v90
    v_permlane32_swap_b32 v89, v91
    v_permlane32_swap_b32 v92, v94
    v_permlane32_swap_b32 v93, v95
    buffer_store_dwordx4 v[88:91], v10, s[4:7], s31 offen
    buffer_store_dwordx4 v[92:95], v10, s[4:7], s31 offen offset:32
    s_branch L_prjB_drain
L_prjB_mid:
    s_add_u32 s30, s30, 0x0
    s_cmp_lg_u32 s68, 0
    s_cbranch_scc1 Lls_mega_23_loc
    buffer_store_dwordx4 v[88:91], v5, s[8:11], s30 offen sc1
    buffer_store_dwordx4 v[92:95], v5, s[8:11], s30 offen offset:1024 sc1
    s_branch Lls_mega_23_end
Lls_mega_23_loc:
    buffer_store_dwordx4 v[88:91], v5, s[8:11], s30 offen
    buffer_store_dwordx4 v[92:95], v5, s[8:11], s30 offen offset:1024
Lls_mega_23_end:
    v_mov_b32 v8, 0
    v_mov_b32 v9, 0
    v_lshlrev_b32 v10, 16, v88
    v_and_b32 v11, 0xffff0000, v88
    v_add_f32 v8, v8, v10
    v_fmac_f32 v9, v10, v10
    v_add_f32 v8, v8, v11
    v_fmac_f32 v9, v11, v11
    v_lshlrev_b32 v10, 16, v89
    v_and_b32 v11, 0xffff0000, v89
    v_add_f32 v8, v8, v10
    v_fmac_f32 v9, v10, v10
    v_add_f32 v8, v8, v11
    v_fmac_f32 v9, v11, v11
    v_lshlrev_b32 v10, 16, v90
    v_and_b32 v11, 0xffff0000, v90
    v_add_f32 v8, v8, v10
    v_fmac_f32 v9, v10, v10
    v_add_f32 v8, v8, v11
    v_fmac_f32 v9, v11, v11
    v_lshlrev_b32 v10, 16, v91
    v_and_b32 v11, 0xffff0000, v91
    v_add_f32 v8, v8, v10
    v_fmac_f32 v9, v10, v10
    v_add_f32 v8, v8, v11
    v_fmac_f32 v9, v11, v11
    v_lshlrev_b32 v10, 16, v92
    v_and_b32 v11, 0xffff0000, v92
    v_add_f32 v8, v8, v10
    v_fmac_f32 v9, v10, v10
    v_add_f32 v8, v8, v11
    v_fmac_f32 v9, v11, v11
    v_lshlrev_b32 v10, 16, v93
    v_and_b32 v11, 0xffff0000, v93
    v_add_f32 v8, v8, v10
    v_fmac_f32 v9, v10, v10
    v_add_f32 v8, v8, v11
    v_fmac_f32 v9, v11, v11
    v_lshlrev_b32 v10, 16, v94
    v_and_b32 v11, 0xffff0000, v94
    v_add_f32 v8, v8, v10
    v_fmac_f32 v9, v10, v10
    v_add_f32 v8, v8, v11
    v_fmac_f32 v9, v11, v11
    v_lshlrev_b32 v10, 16, v95
    v_and_b32 v11, 0xffff0000, v95
    v_add_f32 v8, v8, v10
    v_fmac_f32 v9, v10, v10
    v_add_f32 v8, v8, v11
    v_fmac_f32 v9, v11, v11
    v_mov_b32 v10, v8
    v_mov_b32 v11, v9
    s_nop 0
    v_permlane32_swap_b32 v8, v10
    v_permlane32_swap_b32 v9, v11
    v_add_f32 v8, v8, v10
    v_add_f32 v9, v9, v11
    v_lshlrev_b32 v10, 4, v3
    s_lshl_b32 s31, s15, 12
    s_add_u32 s31, s31, s60
    s_add_u32 s31, s31, 0x1c0000
    s_lshr_b32 s27, s17, 1
    s_lshl_b32 s27, s27, 9
    s_add_u32 s31, s31, s27
    s_and_b32 s27, s17, 1
    s_lshl_b32 s27, s27, 3
    s_add_u32 s31, s31, s27
    s_cmp_lg_u32 s68, 0
    s_cbranch_scc1 Lls_mega_24_loc
    buffer_store_dwordx2 v[8:9], v10, s[8:11], s31 offen sc1
    s_branch Lls_mega_24_end
Lls_mega_24_loc:
    buffer_store_dwordx2 v[8:9], v10, s[8:11], s31 offen
Lls_mega_24_end:
L_prjB_drain:
    s_waitcnt vmcnt(0)
L_prjB_sig:
    s_lshl_b32 s19, s16, 4
    s_add_u32 s19, s19, s17
    s_barrier
    s_cmp_lg_u32 s12, 0
    s_cbranch_scc1 LsprjB_mega_25
    s_lshl_b32 s58, s19, 7
    s_add_u32 s58, s58, s61
    s_add_u32 s58, s58, 327680
    v_mov_b32 v125, 0
    v_mov_b32 v126, s66
    v_mov_b32 v127, s67
    s_mov_b64 exec, 1
    s_cmp_lg_u32 s68, 0
    s_cbranch_scc1 Lls_mega_26_loc
    buffer_store_dwordx2 v[126:127], v125, s[8:11], s58 offen sc1
    s_branch Lls_mega_26_end
Lls_mega_26_loc:
    buffer_store_dwordx2 v[126:127], v125, s[8:11], s58 offen
Lls_mega_26_end:
    s_mov_b64 exec, -1
LsprjB_mega_25:
L_prjB_end:
    s_add_u32 s60, s60, 0x0
    s_add_u32 s61, s61, 0x60000
    s_add_u32 s62, s62, 1
    s_cmp_lt_u32 s62, 2
    s_cbranch_scc1 L_pair
L_exit:
    s_endpgm
L_codeend:
.set CODE_LIMIT, L_codeend - L_pcref - 4
.section .rodata,"a"
.p2align 6
.amdhsa_kernel interleave_layers__grouped_kv_mqa__sliding_block__prompt_kernel
  .amdhsa_next_free_vgpr 256
  .amdhsa_next_free_sgpr 102
  .amdhsa_accum_offset 128
  .amdhsa_group_segment_fixed_size 0
  .amdhsa_kernarg_size 88
  .amdhsa_user_sgpr_count 2
  .amdhsa_user_sgpr_kernarg_segment_ptr 1
  .amdhsa_system_sgpr_workgroup_id_x 1
.end_amdhsa_kernel
```
